```python
import torch

def _softmax(x, axis=-1):
    return torch.softmax(x, dim=axis)

def _gelu(x):
    return torch.nn.functional.gelu(x, approximate='tanh')

def _silu(x):
    return torch.nn.functional.silu(x)

def _sigmoid(x):
    return torch.sigmoid(x)

def _layernorm(x, axis=-1, eps=1e-05):
    m = x.mean(dim=axis, keepdim=True)
    v = x.var(dim=axis, keepdim=True, unbiased=False)
    return (x - m) / torch.sqrt(v + eps)

def _scatter_add(tgt, idx, src, axis=0):
    return tgt.clone().index_add_(axis, idx, src)

def _segment_sum(src, seg, n):
    out = torch.zeros((n,) + src.shape[1:], dtype=src.dtype)
    return out.index_add_(0, seg, src)

def _pad(x, pw):
    flat = tuple((v for pair in reversed(pw) for v in pair))
    return torch.nn.functional.pad(x, flat)
kernel_name = 'adaLN_cond__sliding_block_cached__dense_activation_silu__decode'

def setup_inputs():

    _w = lambda a: (lambda t: t.to(torch.bfloat16) if t.is_floating_point() else t)(torch.as_tensor(a))

    def _A_setup():
        B, Sq, D = (8, 1, 640)
        Hq, Hkv, Sk, Dh = (32, 32, 4096, 128)
        assert Hq % Hkv == 0, (Hq, Hkv)
        return {'x': _w((lambda *s: torch.randn(*s, dtype=torch.bfloat16) * 0.1)(B, Sq, D)), 'k_cache': _w((lambda *s: torch.randn(*s, dtype=torch.bfloat16) * 0.8)(B, Hkv, Sk, Dh)), 'v_cache': _w((lambda *s: torch.randn(*s, dtype=torch.bfloat16) * 3.2)(B, Hkv, Sk, Dh)), 'wq': _w((lambda *s: torch.randn(*s, dtype=torch.bfloat16) * 0.8)(D, Hq * Dh) * D ** (-0.5)), 'wo': _w((lambda *s: torch.randn(*s, dtype=torch.bfloat16) * 3.2)(Hq * Dh, D) * (Hq * Dh) ** (-0.5))}
    _A_in = _A_setup()

    def _B_setup():
        B, S, D, F = (8, 1, 640, 1728)
        return {'x': _w((lambda *s: torch.randn(*s, dtype=torch.bfloat16) * 0.1)(B, S, D)), 'w1': _w((lambda *s: torch.randn(*s, dtype=torch.bfloat16) * 3.2)(D, F) * D ** (-0.5)), 'w2': _w((lambda *s: torch.randn(*s, dtype=torch.bfloat16) * 3.2)(F, D) * F ** (-0.5))}
    _B_in = _B_setup()
    return {'A_x': _A_in['x'], 'A_k_cache': _A_in['k_cache'], 'A_v_cache': _A_in['v_cache'], 'A_wq': _A_in['wq'], 'A_wo': _A_in['wo'], 'B_x': _B_in['x'], 'B_w1': _B_in['w1'], 'B_w2': _B_in['w2'], 'c': _w((lambda *s: torch.randn(*s, dtype=torch.bfloat16) * 0.1)(8, 640) * 8.0), 'w_mod': _w((lambda *s: torch.randn(*s, dtype=torch.bfloat16) * 0.1)(640, 6 * 640) * 640 ** (-0.5) * 8.0)}

def reference(A_x, A_k_cache, A_v_cache, A_wq, A_wo, B_x, B_w1, B_w2, c, w_mod):

    def _A_ref(x, k_cache, v_cache, wq, wo):
        B, Sq, D = x.shape
        Hq, Dh = (32, 128)
        Hkv, Sk = (k_cache.shape[1], k_cache.shape[2])
        W = min(4096, max(256, Sk // 4))
        rep = Hq // Hkv
        q = (lambda x, *d: x.permute(*d))((x @ wq).reshape(B, Sq, Hq, Dh), 0, 2, 1, 3)
        k = (lambda x, n, axis: torch.repeat_interleave(x, n, dim=axis))(k_cache[:, :, Sk - W:, :], rep, axis=1)
        v = (lambda x, n, axis: torch.repeat_interleave(x, n, dim=axis))(v_cache[:, :, Sk - W:, :], rep, axis=1)
        scores = torch.einsum('bhqd,bhkd->bhqk', q, k) * Dh ** (-0.5)
        p = _softmax(scores, axis=-1)
        o = torch.einsum('bhqk,bhkd->bhqd', p, v)
        return (lambda x, *d: x.permute(*d))(o, 0, 2, 1, 3).reshape(B, Sq, Hq * Dh) @ wo

    def _B_ref(x, w1, w2):
        h = torch.einsum('bsd,df->bsf', x, w1)
        h = _silu(h)
        out = torch.einsum('bsf,fd->bsd', h, w2)
        return out
    x = A_x
    mod = (_silu(c) @ w_mod).reshape(c.shape[0], 6, 1, -1)
    sa, ca, ga, sb, cb, gb = (mod[:, 0].clone(), mod[:, 1].clone(), mod[:, 2].clone(), mod[:, 3].clone(), mod[:, 4].clone(), mod[:, 5].clone())
    h = _layernorm(x, axis=-1) * (1 + ca) + sa
    x = x + ga * _A_ref(h, A_k_cache, A_v_cache, A_wq, A_wo)
    h = _layernorm(x, axis=-1) * (1 + cb) + sb
    x = x + gb * _B_ref(h, B_w1, B_w2)
    return x
```

```asm
; @launch grid=(256,1,1) block=(512,1,1) lds=156672
.amdgcn_target "amdgcn-amd-amdhsa--gfx950"
.text
.globl adaLN_cond__sliding_block_cached__dense_activation_silu__decode_kernel
.p2align 8
.type adaLN_cond__sliding_block_cached__dense_activation_silu__decode_kernel,@function
adaLN_cond__sliding_block_cached__dense_activation_silu__decode_kernel:
    s_cmp_ge_u32 s2, 256
    s_cbranch_scc1 L_end
    s_load_dwordx16 s[16:31], s[0:1], 0
    s_load_dwordx8 s[32:39], s[0:1], 64
    s_load_dwordx2 s[40:41], s[0:1], 96
    v_lshrrev_b32 v1, 6, v0
    s_and_b32 s4, s2, 7
    v_readfirstlane_b32 s3, v1
    v_and_b32 v1, 63, v0
    v_lshrrev_b32 v2, 4, v1
    v_and_b32 v3, 15, v1
    v_lshlrev_b32 v4, 6, v3
    v_lshl_add_u32 v4, v2, 4, v4
    v_lshlrev_b32 v5, 4, v1
    v_lshlrev_b32 v6, 2, v1
    v_and_b32 v13, 3, v1
    s_lshr_b32 s5, s2, 3
    s_lshl_b32 s6, s4, 2
    s_and_b32 s8, s5, 3
    s_add_u32 s6, s6, s8
    s_lshr_b32 s7, s5, 2
    s_mul_i32 s84, s8, 1
    s_mul_i32 s9, s4, 4
    s_add_u32 s84, s84, s9
    s_lshl_b32 s8, s7, 5
    s_add_u32 s84, s84, s8
    s_lshl_b32 s14, s84, 20
    s_lshl_b32 s9, s3, 10
    s_sub_u32 s9, s9, 1024
    s_cmp_eq_u32 s3, 0
    s_cselect_b32 s9, 229376, s9
    s_cselect_b32 s13, 1, 7
    s_sub_u32 s12, 0x40000, s9
    s_add_u32 s14, s14, s9
    s_add_u32 s14, s14, 0xC0000
    s_mov_b32 s15, 0
    s_mul_i32 s97, s3, 1280
    s_and_b32 s8, s5, 15
    s_lshr_b32 s8, s8, 1
    s_lshl_b32 s9, s8, 3
    s_add_u32 s9, s9, s4
    s_lshl_b32 s91, s9, 1
    s_and_b32 s10, s5, 1
    s_add_u32 s91, s91, s10
    s_mul_i32 s11, s3, 5120
    s_add_u32 m0, s11, 21504
    v_mov_b32 v15, 384
    v_mov_b32 v8, 0
    v_mov_b32 v9, 0
    v_mov_b32 v10, 0
    v_mov_b32 v11, 0
    ds_write_b128 v15, v[8:11]
    s_nop 1
    v_mov_b32 v8, -1
    v_mov_b32 v9, -1
    v_mov_b32 v10, -1
    v_mov_b32 v11, -1
    s_cmp_lt_u32 s5, 16
    s_cbranch_scc1 L_p_mod
    s_mov_b32 s85, 1
    v_lshrrev_b32 v12, 3, v1
    v_lshlrev_b32 v12, 13, v12
    v_and_b32 v14, 7, v1
    v_lshl_add_u32 v12, v14, 4, v12
    s_lshl_b32 s99, s4, 3
    s_add_u32 s99, s99, s8
    s_lshr_b32 s9, s8, 1
    s_mul_i32 s9, s9, 256
    s_mul_i32 s11, s4, 1024
    s_add_u32 s9, s9, s11
    s_and_b32 s11, s8, 1
    s_lshl_b32 s11, s11, 7
    s_add_u32 s9, s9, s11
    s_mul_i32 s10, s10, 2621440
    s_add_u32 s9, s9, s10
    s_mov_b32 s11, 65536
    s_waitcnt lgkmcnt(0)
    s_add_u32 s92, s22, s9
    s_addc_u32 s93, s23, 0
    s_sub_u32 s94, 5242880, s9
    s_branch L_p_j
L_p_mod:
    s_mov_b32 s85, 2
    v_lshrrev_b32 v12, 2, v1
    v_mul_u32_u24 v12, 7680, v12
    v_lshl_add_u32 v12, v13, 4, v12
    s_lshl_b32 s9, s91, 6
    s_mov_b32 s11, 122880
    s_mov_b32 s99, 0
    s_waitcnt lgkmcnt(0)
    s_add_u32 s92, s34, s9
    s_addc_u32 s93, s35, 0
    s_sub_u32 s94, 4915200, s9
    s_cmp_lt_u32 s91, 120
    s_cbranch_scc1 L_p_j
    s_mov_b32 s85, 8
    s_mov_b32 s94, 0
L_p_j:
    s_mov_b32 s95, 0x20000
    s_mov_b32 s52, s40
    s_mov_b32 s53, s41
    s_mov_b32 s54, 0x207000
    s_mov_b32 s55, 0x20000
    s_mov_b32 s80, s38
    s_mov_b32 s81, s39
    s_mov_b32 s82, 256
    s_mov_b32 s83, 0x20000
    s_mov_b32 s68, s16
    s_mov_b32 s69, s17
    s_mov_b32 s70, 10240
    s_mov_b32 s71, 0x20000
    s_mov_b32 s72, s32
    s_mov_b32 s73, s33
    s_mov_b32 s74, 10240
    s_mov_b32 s75, 0x20000
    s_lshl_b32 s87, s6, 3
    s_add_u32 s87, s87, s7
    s_cmp_eq_u32 s3, 0
    s_cbranch_scc0 L_p_nh
    s_setprio 3
    s_cmp_eq_u32 s85, 8
    s_cbranch_scc0 L_p_nc
    s_sub_u32 s8, s91, 120
    s_mul_i32 s8, s8, 8192
    buffer_store_dwordx4 v[8:11], v5, s[52:55], s8 offen offset:0 sc1
    buffer_store_dwordx4 v[8:11], v5, s[52:55], s8 offen offset:1024 sc1
    buffer_store_dwordx4 v[8:11], v5, s[52:55], s8 offen offset:2048 sc1
    buffer_store_dwordx4 v[8:11], v5, s[52:55], s8 offen offset:3072 sc1
    s_add_u32 s8, s8, 4096
    buffer_store_dwordx4 v[8:11], v5, s[52:55], s8 offen offset:0 sc1
    buffer_store_dwordx4 v[8:11], v5, s[52:55], s8 offen offset:1024 sc1
    buffer_store_dwordx4 v[8:11], v5, s[52:55], s8 offen offset:2048 sc1
    buffer_store_dwordx4 v[8:11], v5, s[52:55], s8 offen offset:3072 sc1
    s_waitcnt vmcnt(0)
    v_mov_b32 v14, 1
    s_mov_b64 exec, 1
    buffer_atomic_add v14, off, s[80:83], 0 sc1
    s_mov_b64 exec, -1
    s_sub_u32 s8, s91, 120
    s_mul_i32 s8, s8, 20480
    s_add_u32 s8, s8, 0x60000
    s_add_u32 s9, s8, 20480
L_p_c2:
    buffer_store_dwordx4 v[8:11], v5, s[52:55], s8 offen sc1
    s_add_u32 s8, s8, 1024
    s_cmp_lt_u32 s8, s9
    s_cbranch_scc1 L_p_c2
L_p_nc:
L_p_nh:
    s_cmp_eq_u32 s85, 2
    s_cbranch_scc0 L_p_nxc
    s_sub_u32 s8, s91, 20
    s_cmp_lt_u32 s8, 20
    s_cbranch_scc0 L_p_nx
    buffer_load_dword v24, v6, s[68:71], s97 offen offset:0
    buffer_load_dword v25, v6, s[68:71], s97 offen offset:256
    buffer_load_dword v26, v6, s[68:71], s97 offen offset:512
    buffer_load_dword v27, v6, s[68:71], s97 offen offset:768
    buffer_load_dword v28, v6, s[68:71], s97 offen offset:1024
L_p_nx:
    buffer_load_dword v56, v6, s[72:75], s97 offen offset:0
    buffer_load_dword v57, v6, s[72:75], s97 offen offset:256
    buffer_load_dword v58, v6, s[72:75], s97 offen offset:512
    buffer_load_dword v59, v6, s[72:75], s97 offen offset:768
    buffer_load_dword v60, v6, s[72:75], s97 offen offset:1024
L_p_nxc:
    s_mul_i32 s8, s3, s11
    s_mul_i32 s8, s8, 5
    buffer_load_dwordx4 v12, s[92:95], s8 offen nt lds
    s_add_u32 m0, m0, 1024
    s_add_u32 s8, s8, s11
    buffer_load_dwordx4 v12, s[92:95], s8 offen nt lds
    s_add_u32 m0, m0, 1024
    s_add_u32 s8, s8, s11
    buffer_load_dwordx4 v12, s[92:95], s8 offen nt lds
    s_add_u32 m0, m0, 1024
    s_add_u32 s8, s8, s11
    buffer_load_dwordx4 v12, s[92:95], s8 offen nt lds
    s_add_u32 m0, m0, 1024
    s_add_u32 s8, s8, s11
    buffer_load_dwordx4 v12, s[92:95], s8 offen nt lds
    s_add_u32 s44, s18, s14
    s_addc_u32 s45, s19, 0
    s_mov_b32 s46, s12
    s_mov_b32 s47, 0x20000
    s_waitcnt lgkmcnt(0)
    s_barrier
    s_cmp_eq_u32 s3, 0
    s_cbranch_scc1 L_c_j
    s_mul_i32 s86, s13, 0
    buffer_load_dwordx4 v[64:67], v4, s[44:47], s86 offen nt
    s_mul_i32 s86, s13, 1024
    buffer_load_dwordx4 v[68:71], v4, s[44:47], s86 offen nt
    s_mul_i32 s86, s13, 2048
    buffer_load_dwordx4 v[72:75], v4, s[44:47], s86 offen nt
L_c_j:
    s_add_u32 s48, s20, s14
    s_addc_u32 s49, s21, 0
    s_mov_b32 s50, s12
    s_mov_b32 s51, 0x20000
    s_sub_i32 s98, s5, 12
    s_and_b32 s8, s98, 3
    s_lshl_b32 s8, s8, 1
    s_lshr_b32 s9, s98, 2
    s_add_u32 s8, s8, s9
    s_cmp_lt_u32 s98, 8
    s_cselect_b32 s98, s8, s98
    s_max_i32 s9, s98, 0
    s_lshl_b32 s9, s9, 6
    s_mul_i32 s8, s4, 655360
    s_add_u32 s8, s8, s9
    s_add_u32 s56, s24, s8
    s_addc_u32 s57, s25, 0
    s_sub_u32 s58, 5242880, s8
    s_mov_b32 s59, 0x20000
    s_mov_b32 s76, s36
    s_mov_b32 s77, s37
    s_mov_b32 s78, 10240
    s_mov_b32 s79, 0x20000
    s_lshl_b32 s8, s84, 20
    s_add_u32 s8, s8, 0xC0000
    s_add_u32 s72, s18, s8
    s_addc_u32 s73, s19, 0
    s_mov_b32 s74, 0x40000
    s_mov_b32 s75, 0x20000
    s_mul_i32 s8, s5, 86
    s_lshr_b32 s8, s8, 8
    s_mul_i32 s9, s8, 3
    s_sub_u32 s93, s5, s9
    s_lshl_b32 s8, s8, 3
    s_add_u32 s8, s8, s4
    s_lshl_b32 s10, s8, 7
    s_add_u32 s60, s28, s10
    s_addc_u32 s61, s29, 0
    s_sub_u32 s62, 2211840, s10
    s_mov_b32 s63, 0x20000
    s_mul_i32 s10, s8, 81920
    s_lshl_b32 s11, s93, 9
    s_add_u32 s10, s10, s11
    s_add_u32 s64, s30, s10
    s_addc_u32 s65, s31, 0
    s_sub_u32 s66, 81920, s11
    s_mov_b32 s67, 0x20000
    s_mul_i32 s101, s8, 20480
    s_lshl_b32 s11, s93, 13
    s_add_u32 s101, s101, s11
    s_add_u32 s101, s101, 0x180000
    s_cmp_lt_u32 s8, 27
    s_cselect_b32 s100, 1, 0
    s_cmp_ge_i32 s98, 0
    s_cselect_b32 s100, 2, s100
    s_mul_i32 s90, s4, 10240
    s_add_u32 s90, s90, 0x40000
    s_lshl_b32 s96, s98, 3
    s_add_u32 s96, s96, s4
    s_getreg_b32 s97, hwreg(HW_REG_XCC_ID)
    s_and_b32 s97, s97, 15
    s_lshl_b32 s10, s3, 6
    v_lshlrev_b32 v7, 9, v2
    v_lshl_add_u32 v7, v3, 2, v7
    v_add_u32 v7, s10, v7
    v_lshrrev_b32 v0, 2, v1
    v_mul_u32_u24 v0, 1280, v0
    v_lshl_add_u32 v0, v13, 4, v0
    v_and_b32 v8, 1, v3
    v_lshlrev_b32 v8, 4, v8
    v_mov_b32 v9, 0xffff
    v_lshlrev_b32 v9, v8, v9
    v_lshrrev_b32 v8, 1, v3
    v_cmp_eq_u32 vcc, 0, v8
    s_nop 1
    v_cndmask_b32 v16, 0, v9, vcc
    v_cmp_eq_u32 vcc, 1, v8
    s_nop 1
    v_cndmask_b32 v17, 0, v9, vcc
    v_cmp_eq_u32 vcc, 2, v8
    s_nop 1
    v_cndmask_b32 v18, 0, v9, vcc
    v_cmp_eq_u32 vcc, 3, v8
    s_nop 1
    v_cndmask_b32 v19, 0, v9, vcc
    s_cmp_eq_u32 s85, 2
    s_cbranch_scc0 L_c_a
    s_waitcnt vmcnt(8)
    s_cmp_eq_u32 s3, 0
    s_cbranch_scc0 L_c_i1
    s_waitcnt vmcnt(5)
L_c_i1:
    v_lshlrev_b32 v32, 16, v56
    v_and_b32 v33, 0xffff0000, v56
    v_lshlrev_b32 v34, 16, v57
    v_and_b32 v35, 0xffff0000, v57
    v_lshlrev_b32 v36, 16, v58
    v_and_b32 v37, 0xffff0000, v58
    v_lshlrev_b32 v38, 16, v59
    v_and_b32 v39, 0xffff0000, v59
    v_lshlrev_b32 v40, 16, v60
    v_and_b32 v41, 0xffff0000, v60
    v_mul_f32 v44, 0xbfb8aa3b, v32
    v_mul_f32 v45, 0xbfb8aa3b, v33
    v_mul_f32 v46, 0xbfb8aa3b, v34
    v_mul_f32 v47, 0xbfb8aa3b, v35
    v_mul_f32 v48, 0xbfb8aa3b, v36
    v_mul_f32 v49, 0xbfb8aa3b, v37
    v_mul_f32 v50, 0xbfb8aa3b, v38
    v_mul_f32 v51, 0xbfb8aa3b, v39
    v_mul_f32 v52, 0xbfb8aa3b, v40
    v_mul_f32 v53, 0xbfb8aa3b, v41
    v_exp_f32 v44, v44
    v_exp_f32 v45, v45
    v_exp_f32 v46, v46
    v_exp_f32 v47, v47
    v_exp_f32 v48, v48
    v_exp_f32 v49, v49
    v_exp_f32 v50, v50
    v_exp_f32 v51, v51
    v_exp_f32 v52, v52
    v_exp_f32 v53, v53
    s_nop 0
    v_add_f32 v44, 1.0, v44
    v_add_f32 v45, 1.0, v45
    v_add_f32 v46, 1.0, v46
    v_add_f32 v47, 1.0, v47
    v_add_f32 v48, 1.0, v48
    v_add_f32 v49, 1.0, v49
    v_add_f32 v50, 1.0, v50
    v_add_f32 v51, 1.0, v51
    v_add_f32 v52, 1.0, v52
    v_add_f32 v53, 1.0, v53
    v_rcp_f32 v44, v44
    v_rcp_f32 v45, v45
    v_rcp_f32 v46, v46
    v_rcp_f32 v47, v47
    v_rcp_f32 v48, v48
    v_rcp_f32 v49, v49
    v_rcp_f32 v50, v50
    v_rcp_f32 v51, v51
    v_rcp_f32 v52, v52
    v_rcp_f32 v53, v53
    s_nop 0
    v_mul_f32 v32, v32, v44
    v_mul_f32 v33, v33, v45
    v_mul_f32 v34, v34, v46
    v_mul_f32 v35, v35, v47
    v_mul_f32 v36, v36, v48
    v_mul_f32 v37, v37, v49
    v_mul_f32 v38, v38, v50
    v_mul_f32 v39, v39, v51
    v_mul_f32 v40, v40, v52
    v_mul_f32 v41, v41, v53
    v_cvt_pk_bf16_f32 v56, v32, v33
    ds_write_b32 v7, v56 offset:1024
    v_cvt_pk_bf16_f32 v57, v34, v35
    ds_write_b32 v7, v57 offset:3072
    v_cvt_pk_bf16_f32 v58, v36, v37
    ds_write_b32 v7, v58 offset:5120
    v_cvt_pk_bf16_f32 v59, v38, v39
    ds_write_b32 v7, v59 offset:7168
    v_cvt_pk_bf16_f32 v60, v40, v41
    ds_write_b32 v7, v60 offset:9216
    s_sub_u32 s8, s91, 20
    s_cmp_lt_u32 s8, 20
    s_cbranch_scc0 L_c_a
    v_lshlrev_b32 v32, 16, v24
    v_and_b32 v33, 0xffff0000, v24
    v_readfirstlane_b32 s8, v32
    v_lshlrev_b32 v34, 16, v25
    v_and_b32 v35, 0xffff0000, v25
    v_lshlrev_b32 v36, 16, v26
    v_and_b32 v37, 0xffff0000, v26
    v_lshlrev_b32 v38, 16, v27
    v_and_b32 v39, 0xffff0000, v27
    v_lshlrev_b32 v40, 16, v28
    v_and_b32 v41, 0xffff0000, v28
    v_pk_add_f32 v[42:43], v[32:33], s[8:9] op_sel_hi:[1,0] neg_lo:[0,1] neg_hi:[0,1]
    v_pk_add_f32 v[44:45], v[34:35], s[8:9] op_sel_hi:[1,0] neg_lo:[0,1] neg_hi:[0,1]
    v_pk_add_f32 v[46:47], v[36:37], s[8:9] op_sel_hi:[1,0] neg_lo:[0,1] neg_hi:[0,1]
    v_pk_add_f32 v[48:49], v[38:39], s[8:9] op_sel_hi:[1,0] neg_lo:[0,1] neg_hi:[0,1]
    v_pk_add_f32 v[50:51], v[40:41], s[8:9] op_sel_hi:[1,0] neg_lo:[0,1] neg_hi:[0,1]
    v_pk_add_f32 v[52:53], v[42:43], v[44:45]
    v_pk_mul_f32 v[54:55], v[42:43], v[42:43]
    v_pk_fma_f32 v[54:55], v[44:45], v[44:45], v[54:55]
    v_pk_add_f32 v[52:53], v[52:53], v[46:47]
    v_pk_fma_f32 v[54:55], v[46:47], v[46:47], v[54:55]
    v_pk_add_f32 v[52:53], v[52:53], v[48:49]
    v_pk_fma_f32 v[54:55], v[48:49], v[48:49], v[54:55]
    v_pk_add_f32 v[52:53], v[52:53], v[50:51]
    v_pk_fma_f32 v[54:55], v[50:51], v[50:51], v[54:55]
    v_add_f32 v52, v52, v53
    v_add_f32 v53, v54, v55
    s_nop 0
    v_add_f32_dpp v52, v52, v52 row_ror:1 row_mask:0xf bank_mask:0xf
    v_add_f32_dpp v53, v53, v53 row_ror:1 row_mask:0xf bank_mask:0xf
    s_nop 0
    v_add_f32_dpp v52, v52, v52 row_ror:2 row_mask:0xf bank_mask:0xf
    v_add_f32_dpp v53, v53, v53 row_ror:2 row_mask:0xf bank_mask:0xf
    s_nop 0
    v_add_f32_dpp v52, v52, v52 row_ror:4 row_mask:0xf bank_mask:0xf
    v_add_f32_dpp v53, v53, v53 row_ror:4 row_mask:0xf bank_mask:0xf
    s_nop 0
    v_add_f32_dpp v52, v52, v52 row_ror:8 row_mask:0xf bank_mask:0xf
    v_add_f32_dpp v53, v53, v53 row_ror:8 row_mask:0xf bank_mask:0xf
    s_nop 0
    v_add_f32_dpp v52, v52, v52 row_bcast:15 row_mask:0xa bank_mask:0xf
    v_add_f32_dpp v53, v53, v53 row_bcast:15 row_mask:0xa bank_mask:0xf
    s_nop 0
    v_add_f32_dpp v52, v52, v52 row_bcast:31 row_mask:0xc bank_mask:0xf
    v_add_f32_dpp v53, v53, v53 row_bcast:31 row_mask:0xc bank_mask:0xf
    s_nop 0
    v_readlane_b32 s9, v52, 63
    v_readlane_b32 s10, v53, 63
    v_mov_b32 v54, 0x3acccccd
    s_nop 0
    v_mul_f32 v52, s9, v54
    v_mul_f32 v53, s10, v54
    v_fma_f32 v53, -v52, v52, v53
    v_add_f32 v52, s8, v52
    v_max_f32 v53, 0, v53
    v_cvt_pk_bf16_f32 v52, 0, v52
    v_cvt_pk_bf16_f32 v54, 0, v53
    v_add_f32 v54, 0x3727c5ac, v54
    v_cvt_pk_bf16_f32 v54, 0, v54
    v_sqrt_f32 v54, v54
    v_pk_add_f32 v[32:33], v[32:33], v[52:53] op_sel_hi:[1,0] neg_lo:[0,1] neg_hi:[0,1]
    v_pk_add_f32 v[34:35], v[34:35], v[52:53] op_sel_hi:[1,0] neg_lo:[0,1] neg_hi:[0,1]
    v_pk_add_f32 v[36:37], v[36:37], v[52:53] op_sel_hi:[1,0] neg_lo:[0,1] neg_hi:[0,1]
    v_pk_add_f32 v[38:39], v[38:39], v[52:53] op_sel_hi:[1,0] neg_lo:[0,1] neg_hi:[0,1]
    v_pk_add_f32 v[40:41], v[40:41], v[52:53] op_sel_hi:[1,0] neg_lo:[0,1] neg_hi:[0,1]
    v_cvt_pk_bf16_f32 v54, 0, v54
    v_rcp_f32 v54, v54
    v_cvt_pk_bf16_f32 v32, 0, v32
    v_cvt_pk_bf16_f32 v33, 0, v33
    v_cvt_pk_bf16_f32 v34, 0, v34
    v_cvt_pk_bf16_f32 v35, 0, v35
    v_cvt_pk_bf16_f32 v36, 0, v36
    v_cvt_pk_bf16_f32 v37, 0, v37
    v_cvt_pk_bf16_f32 v38, 0, v38
    v_cvt_pk_bf16_f32 v39, 0, v39
    v_cvt_pk_bf16_f32 v40, 0, v40
    v_cvt_pk_bf16_f32 v41, 0, v41
    v_pk_mul_f32 v[32:33], v[32:33], v[54:55] op_sel_hi:[1,0]
    v_pk_mul_f32 v[34:35], v[34:35], v[54:55] op_sel_hi:[1,0]
    v_pk_mul_f32 v[36:37], v[36:37], v[54:55] op_sel_hi:[1,0]
    v_pk_mul_f32 v[38:39], v[38:39], v[54:55] op_sel_hi:[1,0]
    v_pk_mul_f32 v[40:41], v[40:41], v[54:55] op_sel_hi:[1,0]
    v_cvt_pk_bf16_f32 v24, v32, v33
    v_cvt_pk_bf16_f32 v25, v34, v35
    v_cvt_pk_bf16_f32 v26, v36, v37
    v_cvt_pk_bf16_f32 v27, v38, v39
    v_cvt_pk_bf16_f32 v28, v40, v41
    ds_write_b32 v7, v24 offset:11264
    ds_write_b32 v7, v25 offset:13312
    ds_write_b32 v7, v26 offset:15360
    ds_write_b32 v7, v27 offset:17408
    ds_write_b32 v7, v28 offset:19456
L_c_a:
    s_cmp_eq_u32 s3, 0
    s_cbranch_scc1 L_helper
    s_lshl_b32 s88, s3, 10
    s_sub_u32 s88, s88, 1024
    s_mov_b64 vcc, -1
    s_waitcnt vmcnt(3) lgkmcnt(0)
    v_mov_b32 v12, 1
    s_mov_b64 exec, 1
    ds_add_u32 v15, v12 offset:4
    s_mov_b64 exec, -1
    s_waitcnt vmcnt(2)
    s_mul_i32 s86, s13, 3072
    buffer_load_dwordx4 v[76:79], v4, s[44:47], s86 offen nt
    s_waitcnt vmcnt(2)
    s_mul_i32 s86, s13, 4096
    buffer_load_dwordx4 v[80:83], v4, s[44:47], s86 offen nt
    s_waitcnt vmcnt(2)
    s_mul_i32 s86, s13, 5120
    buffer_load_dwordx4 v[84:87], v4, s[44:47], s86 offen nt
    s_waitcnt vmcnt(2)
    s_add_u32 s8, s88, 0
    s_add_u32 m0, s8, 62464
    s_add_u32 s8, s8, 229376
    buffer_load_dwordx4 v4, s[72:75], s8 offen nt lds
    s_waitcnt vmcnt(2)
    s_mul_i32 s86, s13, 6144
    buffer_load_dwordx4 v[88:91], v4, s[44:47], s86 offen nt
    s_waitcnt vmcnt(2)
    s_mul_i32 s86, s13, 7168
    buffer_load_dwordx4 v[92:95], v4, s[44:47], s86 offen nt
    s_waitcnt vmcnt(2)
    s_mul_i32 s86, s13, 8192
    buffer_load_dwordx4 v[96:99], v4, s[44:47], s86 offen nt
    s_waitcnt vmcnt(2)
    s_mul_i32 s86, s13, 9216
    buffer_load_dwordx4 v[100:103], v4, s[44:47], s86 offen nt
    s_waitcnt vmcnt(2)
    s_mul_i32 s86, s13, 10240
    buffer_load_dwordx4 v[104:107], v4, s[44:47], s86 offen nt
    s_waitcnt vmcnt(2)
    s_mul_i32 s86, s13, 11264
    buffer_load_dwordx4 v[108:111], v4, s[44:47], s86 offen nt
    s_waitcnt vmcnt(2)
    s_add_u32 s8, s88, 7168
    s_add_u32 m0, s8, 62464
    s_add_u32 s8, s8, 229376
    buffer_load_dwordx4 v4, s[72:75], s8 offen nt lds
    s_waitcnt vmcnt(2)
    s_mul_i32 s86, s13, 12288
    buffer_load_dwordx4 v[112:115], v4, s[44:47], s86 offen nt
    s_waitcnt vmcnt(2)
    s_mul_i32 s86, s13, 13312
    buffer_load_dwordx4 v[116:119], v4, s[44:47], s86 offen nt
    s_waitcnt vmcnt(2)
    s_mul_i32 s86, s13, 14336
    buffer_load_dwordx4 v[120:123], v4, s[44:47], s86 offen nt
    s_waitcnt vmcnt(2)
    s_mul_i32 s86, s13, 15360
    buffer_load_dwordx4 v[124:127], v4, s[44:47], s86 offen nt
    s_waitcnt vmcnt(2)
    s_mul_i32 s86, s13, 16384
    buffer_load_dwordx4 v[128:131], v4, s[44:47], s86 offen nt
    s_waitcnt vmcnt(2)
    s_mul_i32 s86, s13, 17408
    buffer_load_dwordx4 v[132:135], v4, s[44:47], s86 offen nt
    s_waitcnt vmcnt(2)
    s_add_u32 s8, s88, 14336
    s_add_u32 m0, s8, 62464
    s_add_u32 s8, s8, 229376
    buffer_load_dwordx4 v4, s[72:75], s8 offen nt lds
    s_waitcnt vmcnt(2)
    s_mul_i32 s86, s13, 18432
    buffer_load_dwordx4 v[136:139], v4, s[44:47], s86 offen nt
    s_waitcnt vmcnt(2)
    s_mul_i32 s86, s13, 19456
    buffer_load_dwordx4 v[140:143], v4, s[44:47], s86 offen nt
    s_waitcnt vmcnt(2)
    s_mul_i32 s86, s13, 20480
    buffer_load_dwordx4 v[144:147], v4, s[44:47], s86 offen nt
    s_waitcnt vmcnt(2)
    s_mul_i32 s86, s13, 21504
    buffer_load_dwordx4 v[148:151], v4, s[44:47], s86 offen nt
    s_waitcnt vmcnt(2)
    s_mul_i32 s86, s13, 22528
    buffer_load_dwordx4 v[152:155], v4, s[44:47], s86 offen nt
    s_waitcnt vmcnt(2)
    s_mul_i32 s86, s13, 23552
    buffer_load_dwordx4 v[156:159], v4, s[44:47], s86 offen nt
    s_waitcnt vmcnt(2)
    s_add_u32 s8, s88, 21504
    s_add_u32 m0, s8, 62464
    s_add_u32 s8, s8, 229376
    buffer_load_dwordx4 v4, s[72:75], s8 offen nt lds
    s_waitcnt vmcnt(2)
    s_mul_i32 s86, s13, 24576
    buffer_load_dwordx4 v[160:163], v4, s[44:47], s86 offen nt
    s_waitcnt vmcnt(2)
    s_mul_i32 s86, s13, 25600
    buffer_load_dwordx4 v[164:167], v4, s[44:47], s86 offen nt
    s_waitcnt vmcnt(2)
    s_mul_i32 s86, s13, 26624
    buffer_load_dwordx4 v[168:171], v4, s[44:47], s86 offen nt
    s_waitcnt vmcnt(2)
    s_mul_i32 s86, s13, 27648
    buffer_load_dwordx4 v[172:175], v4, s[44:47], s86 offen nt
    s_waitcnt vmcnt(2)
    s_mul_i32 s86, s13, 28672
    buffer_load_dwordx4 v[176:179], v4, s[44:47], s86 offen nt
    s_waitcnt vmcnt(2)
    s_mul_i32 s86, s13, 29696
    buffer_load_dwordx4 v[180:183], v4, s[44:47], s86 offen nt
    s_waitcnt vmcnt(2)
    s_add_u32 s8, s88, 28672
    s_add_u32 m0, s8, 62464
    s_add_u32 s8, s8, 229376
    buffer_load_dwordx4 v4, s[72:75], s8 offen nt lds
    s_waitcnt vmcnt(2)
    s_mul_i32 s86, s13, 30720
    buffer_load_dwordx4 v[184:187], v4, s[44:47], s86 offen nt
    s_waitcnt vmcnt(2)
    s_mul_i32 s86, s13, 31744
    buffer_load_dwordx4 v[188:191], v4, s[44:47], s86 offen nt
    s_waitcnt vmcnt(2)
    v_mov_b32 v12, 1
    s_mov_b64 exec, 1
    ds_add_u32 v15, v12 offset:8
    s_mov_b64 exec, -1
    s_mul_i32 s86, s13, 0
    buffer_load_dwordx4 v[192:195], v5, s[48:51], s86 offen nt
    s_waitcnt vmcnt(2)
    s_mul_i32 s86, s13, 1024
    buffer_load_dwordx4 v[196:199], v5, s[48:51], s86 offen nt
    s_waitcnt vmcnt(2)
    s_mul_i32 s86, s13, 2048
    buffer_load_dwordx4 v[200:203], v5, s[48:51], s86 offen nt
    s_waitcnt vmcnt(2)
    s_mul_i32 s86, s13, 3072
    buffer_load_dwordx4 v[204:207], v5, s[48:51], s86 offen nt
    s_waitcnt vmcnt(2)
    s_mul_i32 s86, s13, 4096
    buffer_load_dwordx4 v[208:211], v5, s[48:51], s86 offen nt
    s_waitcnt vmcnt(2)
    s_mul_i32 s86, s13, 5120
    buffer_load_dwordx4 v[212:215], v5, s[48:51], s86 offen nt
    s_waitcnt vmcnt(2)
    s_mul_i32 s86, s13, 6144
    buffer_load_dwordx4 v[216:219], v5, s[48:51], s86 offen nt
    s_waitcnt vmcnt(2)
    s_mul_i32 s86, s13, 7168
    buffer_load_dwordx4 v[220:223], v5, s[48:51], s86 offen nt
    s_waitcnt vmcnt(2)
    s_mul_i32 s86, s13, 8192
    buffer_load_dwordx4 v[224:227], v5, s[48:51], s86 offen nt
    s_waitcnt vmcnt(2)
    s_mul_i32 s86, s13, 9216
    buffer_load_dwordx4 v[228:231], v5, s[48:51], s86 offen nt
    s_waitcnt vmcnt(2)
    s_mul_i32 s86, s13, 10240
    buffer_load_dwordx4 v[232:235], v5, s[48:51], s86 offen nt
    s_waitcnt vmcnt(2)
    s_mul_i32 s86, s13, 11264
    buffer_load_dwordx4 v[236:239], v5, s[48:51], s86 offen nt
    s_waitcnt vmcnt(2)
    s_mul_i32 s86, s13, 12288
    buffer_load_dwordx4 v[240:243], v5, s[48:51], s86 offen nt
    s_mul_i32 s86, s13, 13312
    buffer_load_dwordx4 v[244:247], v5, s[48:51], s86 offen nt
    s_mul_i32 s86, s13, 14336
    buffer_load_dwordx4 v[248:251], v5, s[48:51], s86 offen nt
    s_mul_i32 s86, s13, 15360
    buffer_load_dwordx4 v[252:255], v5, s[48:51], s86 offen nt
    s_mov_b32 s14, 3200000
Lsp_1:
    ds_read_b32 v12, v15 offset:0
    s_waitcnt lgkmcnt(0)
    v_readfirstlane_b32 s8, v12
    s_nop 0
    s_cmp_ge_u32 s8, 2
    s_cbranch_scc1 Lspd_2
    s_sleep 1
    s_sub_u32 s14, s14, 1
    s_cbranch_scc0 Lsp_1
    s_or_b32 s15, s15, 1024
Lspd_2:
    s_branch L_qk
L_helper:
    s_waitcnt vmcnt(0)
    s_cmp_eq_u32 s85, 8
    s_cbranch_scc0 L_h_nb
    v_mov_b32 v14, 1
    s_mov_b64 exec, 1
    buffer_atomic_add v14, off, s[80:83], 0 offset:128 sc1
    s_mov_b64 exec, -1
L_h_nb:
    buffer_load_dword v12, off, s[80:83], 0 sc1
    s_mov_b32 s14, 3200000
Lsp_3:
    ds_read_b32 v14, v15 offset:4
    s_waitcnt lgkmcnt(0)
    v_readfirstlane_b32 s8, v14
    s_nop 0
    s_cmp_ge_u32 s8, 7
    s_cbranch_scc1 Lspd_4
    s_sleep 1
    s_sub_u32 s14, s14, 1
    s_cbranch_scc0 Lsp_3
    s_or_b32 s15, s15, 256
Lspd_4:
    v_lshrrev_b32 v8, 2, v3
    s_cmp_eq_u32 s85, 2
    s_cbranch_scc1 L_h_mod
    v_lshlrev_b32 v10, 10, v2
    v_lshl_add_u32 v10, v8, 7, v10
    v_lshl_add_u32 v10, v13, 3, v10
    ds_read_b64_tr_b16 v[64:65], v10 offset:21504
    ds_read_b64_tr_b16 v[66:67], v10 offset:22016
    ds_read_b64_tr_b16 v[68:69], v10 offset:21536
    ds_read_b64_tr_b16 v[70:71], v10 offset:22048
    ds_read_b64_tr_b16 v[72:73], v10 offset:21568
    ds_read_b64_tr_b16 v[74:75], v10 offset:22080
    ds_read_b64_tr_b16 v[76:77], v10 offset:21600
    ds_read_b64_tr_b16 v[78:79], v10 offset:22112
    ds_read_b64_tr_b16 v[80:81], v10 offset:25600
    ds_read_b64_tr_b16 v[82:83], v10 offset:26112
    ds_read_b64_tr_b16 v[84:85], v10 offset:25632
    ds_read_b64_tr_b16 v[86:87], v10 offset:26144
    ds_read_b64_tr_b16 v[88:89], v10 offset:25664
    ds_read_b64_tr_b16 v[90:91], v10 offset:26176
    ds_read_b64_tr_b16 v[92:93], v10 offset:25696
    ds_read_b64_tr_b16 v[94:95], v10 offset:26208
    ds_read_b64_tr_b16 v[96:97], v10 offset:29696
    ds_read_b64_tr_b16 v[98:99], v10 offset:30208
    ds_read_b64_tr_b16 v[100:101], v10 offset:29728
    ds_read_b64_tr_b16 v[102:103], v10 offset:30240
    ds_read_b64_tr_b16 v[104:105], v10 offset:29760
    ds_read_b64_tr_b16 v[106:107], v10 offset:30272
    ds_read_b64_tr_b16 v[108:109], v10 offset:29792
    ds_read_b64_tr_b16 v[110:111], v10 offset:30304
    ds_read_b64_tr_b16 v[112:113], v10 offset:33792
    ds_read_b64_tr_b16 v[114:115], v10 offset:34304
    ds_read_b64_tr_b16 v[116:117], v10 offset:33824
    ds_read_b64_tr_b16 v[118:119], v10 offset:34336
    ds_read_b64_tr_b16 v[120:121], v10 offset:33856
    ds_read_b64_tr_b16 v[122:123], v10 offset:34368
    ds_read_b64_tr_b16 v[124:125], v10 offset:33888
    ds_read_b64_tr_b16 v[126:127], v10 offset:34400
    ds_read_b64_tr_b16 v[128:129], v10 offset:37888
    ds_read_b64_tr_b16 v[130:131], v10 offset:38400
    ds_read_b64_tr_b16 v[132:133], v10 offset:37920
    ds_read_b64_tr_b16 v[134:135], v10 offset:38432
    ds_read_b64_tr_b16 v[136:137], v10 offset:37952
    ds_read_b64_tr_b16 v[138:139], v10 offset:38464
    ds_read_b64_tr_b16 v[140:141], v10 offset:37984
    ds_read_b64_tr_b16 v[142:143], v10 offset:38496
    ds_read_b64_tr_b16 v[144:145], v10 offset:41984
    ds_read_b64_tr_b16 v[146:147], v10 offset:42496
    ds_read_b64_tr_b16 v[148:149], v10 offset:42016
    ds_read_b64_tr_b16 v[150:151], v10 offset:42528
    ds_read_b64_tr_b16 v[152:153], v10 offset:42048
    ds_read_b64_tr_b16 v[154:155], v10 offset:42560
    ds_read_b64_tr_b16 v[156:157], v10 offset:42080
    ds_read_b64_tr_b16 v[158:159], v10 offset:42592
    ds_read_b64_tr_b16 v[160:161], v10 offset:46080
    ds_read_b64_tr_b16 v[162:163], v10 offset:46592
    ds_read_b64_tr_b16 v[164:165], v10 offset:46112
    ds_read_b64_tr_b16 v[166:167], v10 offset:46624
    ds_read_b64_tr_b16 v[168:169], v10 offset:46144
    ds_read_b64_tr_b16 v[170:171], v10 offset:46656
    ds_read_b64_tr_b16 v[172:173], v10 offset:46176
    ds_read_b64_tr_b16 v[174:175], v10 offset:46688
    ds_read_b64_tr_b16 v[176:177], v10 offset:50176
    ds_read_b64_tr_b16 v[178:179], v10 offset:50688
    ds_read_b64_tr_b16 v[180:181], v10 offset:50208
    ds_read_b64_tr_b16 v[182:183], v10 offset:50720
    ds_read_b64_tr_b16 v[184:185], v10 offset:50240
    ds_read_b64_tr_b16 v[186:187], v10 offset:50752
    ds_read_b64_tr_b16 v[188:189], v10 offset:50272
    ds_read_b64_tr_b16 v[190:191], v10 offset:50784
    ds_read_b64_tr_b16 v[208:209], v10 offset:54272
    ds_read_b64_tr_b16 v[210:211], v10 offset:54784
    ds_read_b64_tr_b16 v[212:213], v10 offset:54304
    ds_read_b64_tr_b16 v[214:215], v10 offset:54816
    ds_read_b64_tr_b16 v[216:217], v10 offset:54336
    ds_read_b64_tr_b16 v[218:219], v10 offset:54848
    ds_read_b64_tr_b16 v[220:221], v10 offset:54368
    ds_read_b64_tr_b16 v[222:223], v10 offset:54880
    ds_read_b64_tr_b16 v[224:225], v10 offset:58368
    ds_read_b64_tr_b16 v[226:227], v10 offset:58880
    ds_read_b64_tr_b16 v[228:229], v10 offset:58400
    ds_read_b64_tr_b16 v[230:231], v10 offset:58912
    ds_read_b64_tr_b16 v[232:233], v10 offset:58432
    ds_read_b64_tr_b16 v[234:235], v10 offset:58944
    ds_read_b64_tr_b16 v[236:237], v10 offset:58464
    ds_read_b64_tr_b16 v[238:239], v10 offset:58976
    s_branch L_h_cnt
L_h_mod:
    v_lshlrev_b32 v10, 9, v2
    v_lshl_add_u32 v10, v8, 6, v10
    v_lshl_add_u32 v10, v13, 3, v10
    ds_read_b128 v[24:27], v4 offset:1024
    ds_read_b64_tr_b16 v[64:65], v10 offset:21504
    ds_read_b64_tr_b16 v[66:67], v10 offset:21760
    ds_read_b64_tr_b16 v[68:69], v10 offset:21536
    ds_read_b64_tr_b16 v[70:71], v10 offset:21792
    ds_read_b64_tr_b16 v[72:73], v10 offset:23552
    ds_read_b64_tr_b16 v[74:75], v10 offset:23808
    ds_read_b64_tr_b16 v[76:77], v10 offset:23584
    ds_read_b64_tr_b16 v[78:79], v10 offset:23840
    ds_read_b128 v[28:31], v4 offset:2048
    ds_read_b64_tr_b16 v[80:81], v10 offset:25600
    ds_read_b64_tr_b16 v[82:83], v10 offset:25856
    ds_read_b64_tr_b16 v[84:85], v10 offset:25632
    ds_read_b64_tr_b16 v[86:87], v10 offset:25888
    ds_read_b64_tr_b16 v[88:89], v10 offset:27648
    ds_read_b64_tr_b16 v[90:91], v10 offset:27904
    ds_read_b64_tr_b16 v[92:93], v10 offset:27680
    ds_read_b64_tr_b16 v[94:95], v10 offset:27936
    s_waitcnt lgkmcnt(9)
    v_mfma_f32_16x16x32_bf16 v[224:227], v[64:67], v[24:27], 0
    v_mfma_f32_16x16x32_bf16 v[228:231], v[68:71], v[24:27], 0
    v_mfma_f32_16x16x32_bf16 v[232:235], v[72:75], v[24:27], 0
    v_mfma_f32_16x16x32_bf16 v[236:239], v[76:79], v[24:27], 0
    ds_read_b128 v[32:35], v4 offset:3072
    ds_read_b64_tr_b16 v[96:97], v10 offset:29696
    ds_read_b64_tr_b16 v[98:99], v10 offset:29952
    ds_read_b64_tr_b16 v[100:101], v10 offset:29728
    ds_read_b64_tr_b16 v[102:103], v10 offset:29984
    ds_read_b64_tr_b16 v[104:105], v10 offset:31744
    ds_read_b64_tr_b16 v[106:107], v10 offset:32000
    ds_read_b64_tr_b16 v[108:109], v10 offset:31776
    ds_read_b64_tr_b16 v[110:111], v10 offset:32032
    s_waitcnt lgkmcnt(9)
    v_mfma_f32_16x16x32_bf16 v[224:227], v[80:83], v[28:31], v[224:227]
    v_mfma_f32_16x16x32_bf16 v[228:231], v[84:87], v[28:31], v[228:231]
    v_mfma_f32_16x16x32_bf16 v[232:235], v[88:91], v[28:31], v[232:235]
    v_mfma_f32_16x16x32_bf16 v[236:239], v[92:95], v[28:31], v[236:239]
    ds_read_b128 v[36:39], v4 offset:4096
    ds_read_b64_tr_b16 v[112:113], v10 offset:33792
    ds_read_b64_tr_b16 v[114:115], v10 offset:34048
    ds_read_b64_tr_b16 v[116:117], v10 offset:33824
    ds_read_b64_tr_b16 v[118:119], v10 offset:34080
    ds_read_b64_tr_b16 v[120:121], v10 offset:35840
    ds_read_b64_tr_b16 v[122:123], v10 offset:36096
    ds_read_b64_tr_b16 v[124:125], v10 offset:35872
    ds_read_b64_tr_b16 v[126:127], v10 offset:36128
    s_waitcnt lgkmcnt(9)
    v_mfma_f32_16x16x32_bf16 v[224:227], v[96:99], v[32:35], v[224:227]
    v_mfma_f32_16x16x32_bf16 v[228:231], v[100:103], v[32:35], v[228:231]
    v_mfma_f32_16x16x32_bf16 v[232:235], v[104:107], v[32:35], v[232:235]
    v_mfma_f32_16x16x32_bf16 v[236:239], v[108:111], v[32:35], v[236:239]
    ds_read_b128 v[40:43], v4 offset:5120
    ds_read_b64_tr_b16 v[128:129], v10 offset:37888
    ds_read_b64_tr_b16 v[130:131], v10 offset:38144
    ds_read_b64_tr_b16 v[132:133], v10 offset:37920
    ds_read_b64_tr_b16 v[134:135], v10 offset:38176
    ds_read_b64_tr_b16 v[136:137], v10 offset:39936
    ds_read_b64_tr_b16 v[138:139], v10 offset:40192
    ds_read_b64_tr_b16 v[140:141], v10 offset:39968
    ds_read_b64_tr_b16 v[142:143], v10 offset:40224
    s_waitcnt lgkmcnt(9)
    v_mfma_f32_16x16x32_bf16 v[224:227], v[112:115], v[36:39], v[224:227]
    v_mfma_f32_16x16x32_bf16 v[228:231], v[116:119], v[36:39], v[228:231]
    v_mfma_f32_16x16x32_bf16 v[232:235], v[120:123], v[36:39], v[232:235]
    v_mfma_f32_16x16x32_bf16 v[236:239], v[124:127], v[36:39], v[236:239]
    ds_read_b128 v[44:47], v4 offset:6144
    ds_read_b64_tr_b16 v[144:145], v10 offset:41984
    ds_read_b64_tr_b16 v[146:147], v10 offset:42240
    ds_read_b64_tr_b16 v[148:149], v10 offset:42016
    ds_read_b64_tr_b16 v[150:151], v10 offset:42272
    ds_read_b64_tr_b16 v[152:153], v10 offset:44032
    ds_read_b64_tr_b16 v[154:155], v10 offset:44288
    ds_read_b64_tr_b16 v[156:157], v10 offset:44064
    ds_read_b64_tr_b16 v[158:159], v10 offset:44320
    s_waitcnt lgkmcnt(9)
    v_mfma_f32_16x16x32_bf16 v[224:227], v[128:131], v[40:43], v[224:227]
    v_mfma_f32_16x16x32_bf16 v[228:231], v[132:135], v[40:43], v[228:231]
    v_mfma_f32_16x16x32_bf16 v[232:235], v[136:139], v[40:43], v[232:235]
    v_mfma_f32_16x16x32_bf16 v[236:239], v[140:143], v[40:43], v[236:239]
    ds_read_b128 v[48:51], v4 offset:7168
    ds_read_b64_tr_b16 v[160:161], v10 offset:46080
    ds_read_b64_tr_b16 v[162:163], v10 offset:46336
    ds_read_b64_tr_b16 v[164:165], v10 offset:46112
    ds_read_b64_tr_b16 v[166:167], v10 offset:46368
    ds_read_b64_tr_b16 v[168:169], v10 offset:48128
    ds_read_b64_tr_b16 v[170:171], v10 offset:48384
    ds_read_b64_tr_b16 v[172:173], v10 offset:48160
    ds_read_b64_tr_b16 v[174:175], v10 offset:48416
    s_waitcnt lgkmcnt(9)
    v_mfma_f32_16x16x32_bf16 v[224:227], v[144:147], v[44:47], v[224:227]
    v_mfma_f32_16x16x32_bf16 v[228:231], v[148:151], v[44:47], v[228:231]
    v_mfma_f32_16x16x32_bf16 v[232:235], v[152:155], v[44:47], v[232:235]
    v_mfma_f32_16x16x32_bf16 v[236:239], v[156:159], v[44:47], v[236:239]
    ds_read_b128 v[52:55], v4 offset:8192
    ds_read_b64_tr_b16 v[176:177], v10 offset:50176
    ds_read_b64_tr_b16 v[178:179], v10 offset:50432
    ds_read_b64_tr_b16 v[180:181], v10 offset:50208
    ds_read_b64_tr_b16 v[182:183], v10 offset:50464
    ds_read_b64_tr_b16 v[184:185], v10 offset:52224
    ds_read_b64_tr_b16 v[186:187], v10 offset:52480
    ds_read_b64_tr_b16 v[188:189], v10 offset:52256
    ds_read_b64_tr_b16 v[190:191], v10 offset:52512
    s_waitcnt lgkmcnt(9)
    v_mfma_f32_16x16x32_bf16 v[224:227], v[160:163], v[48:51], v[224:227]
    v_mfma_f32_16x16x32_bf16 v[228:231], v[164:167], v[48:51], v[228:231]
    v_mfma_f32_16x16x32_bf16 v[232:235], v[168:171], v[48:51], v[232:235]
    v_mfma_f32_16x16x32_bf16 v[236:239], v[172:175], v[48:51], v[236:239]
    ds_read_b128 v[56:59], v4 offset:9216
    ds_read_b64_tr_b16 v[192:193], v10 offset:54272
    ds_read_b64_tr_b16 v[194:195], v10 offset:54528
    ds_read_b64_tr_b16 v[196:197], v10 offset:54304
    ds_read_b64_tr_b16 v[198:199], v10 offset:54560
    ds_read_b64_tr_b16 v[200:201], v10 offset:56320
    ds_read_b64_tr_b16 v[202:203], v10 offset:56576
    ds_read_b64_tr_b16 v[204:205], v10 offset:56352
    ds_read_b64_tr_b16 v[206:207], v10 offset:56608
    s_waitcnt lgkmcnt(9)
    v_mfma_f32_16x16x32_bf16 v[224:227], v[176:179], v[52:55], v[224:227]
    v_mfma_f32_16x16x32_bf16 v[228:231], v[180:183], v[52:55], v[228:231]
    v_mfma_f32_16x16x32_bf16 v[232:235], v[184:187], v[52:55], v[232:235]
    v_mfma_f32_16x16x32_bf16 v[236:239], v[188:191], v[52:55], v[236:239]
    ds_read_b128 v[60:63], v4 offset:10240
    ds_read_b64_tr_b16 v[208:209], v10 offset:58368
    ds_read_b64_tr_b16 v[210:211], v10 offset:58624
    ds_read_b64_tr_b16 v[212:213], v10 offset:58400
    ds_read_b64_tr_b16 v[214:215], v10 offset:58656
    ds_read_b64_tr_b16 v[216:217], v10 offset:60416
    ds_read_b64_tr_b16 v[218:219], v10 offset:60672
    ds_read_b64_tr_b16 v[220:221], v10 offset:60448
    ds_read_b64_tr_b16 v[222:223], v10 offset:60704
    s_waitcnt lgkmcnt(9)
    v_mfma_f32_16x16x32_bf16 v[224:227], v[192:195], v[56:59], v[224:227]
    v_mfma_f32_16x16x32_bf16 v[228:231], v[196:199], v[56:59], v[228:231]
    v_mfma_f32_16x16x32_bf16 v[232:235], v[200:203], v[56:59], v[232:235]
    v_mfma_f32_16x16x32_bf16 v[236:239], v[204:207], v[56:59], v[236:239]
    s_waitcnt lgkmcnt(0)
    v_mfma_f32_16x16x32_bf16 v[224:227], v[208:211], v[60:63], v[224:227]
    v_mfma_f32_16x16x32_bf16 v[228:231], v[212:215], v[60:63], v[228:231]
    v_mfma_f32_16x16x32_bf16 v[232:235], v[216:219], v[60:63], v[232:235]
    v_mfma_f32_16x16x32_bf16 v[236:239], v[220:223], v[60:63], v[236:239]
    v_and_b32 v8, 7, v3
    v_lshrrev_b32 v9, 3, v3
    v_lshlrev_b32 v11, 6, v8
    v_lshl_add_u32 v11, v9, 5, v11
    v_lshl_add_u32 v11, v2, 3, v11
    s_lshl_b32 s9, s91, 9
    s_add_u32 s8, s9, 1024
    v_add_u32 v14, s8, v11
    s_nop 1
    v_add_f32_dpp v24, v232, v224 row_ror:8 row_mask:0xf bank_mask:0x3
    v_add_f32_dpp v24, v228, v236 row_ror:8 row_mask:0xf bank_mask:0xc
    v_add_f32_dpp v25, v233, v225 row_ror:8 row_mask:0xf bank_mask:0x3
    v_add_f32_dpp v25, v229, v237 row_ror:8 row_mask:0xf bank_mask:0xc
    v_add_f32_dpp v26, v234, v226 row_ror:8 row_mask:0xf bank_mask:0x3
    v_add_f32_dpp v26, v230, v238 row_ror:8 row_mask:0xf bank_mask:0xc
    v_add_f32_dpp v27, v235, v227 row_ror:8 row_mask:0xf bank_mask:0x3
    v_add_f32_dpp v27, v231, v239 row_ror:8 row_mask:0xf bank_mask:0xc
    v_cvt_pk_bf16_f32 v40, v24, v25
    v_cvt_pk_bf16_f32 v41, v26, v27
    s_sub_u32 s8, s91, 20
    s_cmp_lt_u32 s8, 20
    s_cbranch_scc0 L_h_pub
    ds_read_b64 v[42:43], v14
    v_lshlrev_b32 v24, 16, v40
    v_and_b32 v25, 0xffff0000, v40
    v_lshlrev_b32 v26, 16, v41
    v_and_b32 v27, 0xffff0000, v41
    v_add_f32 v24, 1.0, v24
    v_add_f32 v25, 1.0, v25
    v_add_f32 v26, 1.0, v26
    v_add_f32 v27, 1.0, v27
    v_cvt_pk_bf16_f32 v40, v24, v25
    v_cvt_pk_bf16_f32 v41, v26, v27
    v_lshlrev_b32 v24, 16, v40
    v_and_b32 v25, 0xffff0000, v40
    v_lshlrev_b32 v26, 16, v41
    v_and_b32 v27, 0xffff0000, v41
    s_waitcnt lgkmcnt(0)
    v_lshlrev_b32 v28, 16, v42
    v_and_b32 v29, 0xffff0000, v42
    v_lshlrev_b32 v30, 16, v43
    v_and_b32 v31, 0xffff0000, v43
    v_mul_f32 v24, v24, v28
    v_mul_f32 v25, v25, v29
    v_mul_f32 v26, v26, v30
    v_mul_f32 v27, v27, v31
    v_cvt_pk_bf16_f32 v40, v24, v25
    v_cvt_pk_bf16_f32 v41, v26, v27
L_h_pub:
    v_min_u32 v40, -2, v40
    v_min_u32 v41, -2, v41
    v_add_u32 v11, 152576, v11
    v_add_u32 v14, 152576, v5
    ds_write_b64 v11, v[40:41]
    ds_read_b128 v[40:43], v14
L_h_cnt:
    s_mov_b32 s14, 400000
L_wc:
    s_waitcnt vmcnt(0)
    v_readfirstlane_b32 s8, v12
    s_nop 0
    s_cmp_ge_u32 s8, 8
    s_cbranch_scc1 L_wcd
    s_sleep 2
    buffer_load_dword v12, off, s[80:83], 0 sc1
    s_sub_u32 s14, s14, 1
    s_cbranch_scc0 L_wc
    s_or_b32 s15, s15, 1
L_wcd:
    s_cmp_eq_u32 s85, 2
    s_cbranch_scc0 L_h_np
    s_mov_b32 exec_hi, 0
    s_waitcnt lgkmcnt(0)
    buffer_store_dwordx4 v[40:43], v5, s[52:55], s9 offen sc1
    s_mov_b64 exec, -1
L_h_np:
    s_lshl_b32 s8, s87, 2
    s_add_u32 s8, s8, 61440
    v_mov_b32 v12, s97
    s_mov_b64 exec, 1
    buffer_store_dword v12, off, s[52:55], s8 sc1
    s_mov_b64 exec, -1
    v_mov_b32 v192, -1
    v_mov_b32 v193, -1
    v_mov_b32 v194, -1
    v_mov_b32 v195, -1
    s_cmp_eq_u32 s100, 1
    s_cbranch_scc0 L_h_no
    buffer_store_dwordx4 v[192:195], v5, s[52:55], s101 offen offset:0 sc1
    buffer_store_dwordx4 v[192:195], v5, s[52:55], s101 offen offset:1024 sc1
    buffer_store_dwordx4 v[192:195], v5, s[52:55], s101 offen offset:2048 sc1
    buffer_store_dwordx4 v[192:195], v5, s[52:55], s101 offen offset:3072 sc1
    s_cmp_eq_u32 s93, 2
    s_cbranch_scc1 L_h_no
    s_add_u32 s8, s101, 4096
    buffer_store_dwordx4 v[192:195], v5, s[52:55], s8 offen offset:0 sc1
    buffer_store_dwordx4 v[192:195], v5, s[52:55], s8 offen offset:1024 sc1
    buffer_store_dwordx4 v[192:195], v5, s[52:55], s8 offen offset:2048 sc1
    buffer_store_dwordx4 v[192:195], v5, s[52:55], s8 offen offset:3072 sc1
L_h_no:
    s_cmp_lt_i32 s98, 0
    s_cbranch_scc1 L_h_nwo
    s_mov_b32 m0, 103424
    s_mov_b32 s8, 0
L_h_wo:
    s_waitcnt vmcnt(9)
    buffer_load_dwordx4 v0, s[56:59], s8 offen  lds
    s_add_u32 m0, m0, 1024
    s_sub_u32 s9, m0, 103424
    s_and_b32 s10, s9, 0x1fff
    s_cselect_b32 s10, 0, 0
    s_add_u32 s8, s8, s10
    s_add_u32 s8, s8, 20480
    s_cmp_lt_u32 s9, 32768
    s_cbranch_scc1 L_h_wo
L_h_nwo:
    v_and_b32 v14, 0x7c, v6
    s_lshl_b32 s43, s4, 7
    s_add_u32 s43, s43, 61440
    s_bitcmp1_b32 s85, 0
    s_cbranch_scc0 L_h_getq0
    v_and_b32 v8, 7, v3
    v_lshrrev_b32 v9, 3, v3
    v_mul_u32_u24 v12, 10240, v9
    v_lshl_add_u32 v12, v8, 6, v12
    v_lshl_add_u32 v12, v2, 4, v12
    v_lshlrev_b32 v196, 8, v8
    v_lshl_add_u32 v196, v9, 6, v196
    v_lshl_add_u32 v196, v2, 4, v196
    v_add_u32 v196, 152576, v196
    v_add_u32 v197, 152576, v5
    v_lshlrev_b32 v198, 10, v2
    v_lshl_add_u32 v198, v3, 4, v198
    s_and_b32 s10, s5, 1
    s_mul_i32 s8, s10, 5120
    s_add_u32 s42, s8, 2560
    s_lshr_b32 s11, s99, 1
    s_and_b32 s9, s5, 15
    s_lshl_b32 s9, s9, 2
    s_add_u32 s9, s9, s43
    s_add_u32 s9, s9, 2048
    s_lshl_b32 s11, s11, 13
    s_lshl_b32 s10, s10, 9
    s_add_u32 s11, s11, s10
    s_and_b32 s10, s99, 1
    s_lshl_b32 s10, s10, 8
    s_add_u32 s11, s11, s10
    s_add_u32 s11, s11, 0x100000
    s_add_u32 s10, s11, 4096
    s_mov_b32 s14, 400000
Lpoll_5:
    buffer_load_dwordx4 v[24:27], v12, s[52:55], s8 offen offset:0 sc1
    buffer_load_dwordx4 v[28:31], v12, s[52:55], s8 offen offset:512 sc1
    buffer_load_dwordx4 v[32:35], v12, s[52:55], s8 offen offset:1024 sc1
    buffer_load_dwordx4 v[36:39], v12, s[52:55], s8 offen offset:1536 sc1
    buffer_load_dwordx4 v[40:43], v12, s[52:55], s8 offen offset:2048 sc1
    buffer_load_dwordx4 v[44:47], v12, s[52:55], s42 offen offset:0 sc1
    buffer_load_dwordx4 v[48:51], v12, s[52:55], s42 offen offset:512 sc1
    buffer_load_dwordx4 v[52:55], v12, s[52:55], s42 offen offset:1024 sc1
    buffer_load_dwordx4 v[56:59], v12, s[52:55], s42 offen offset:1536 sc1
    buffer_load_dwordx4 v[60:63], v12, s[52:55], s42 offen offset:2048 sc1
    s_waitcnt vmcnt(0)
Lchk_6:
    v_max3_u32 v241, v24, v25, v26
    v_max3_u32 v241, v241, v27, v28
    v_max3_u32 v241, v241, v29, v30
    v_max3_u32 v241, v241, v31, v32
    v_max3_u32 v241, v241, v33, v34
    v_max3_u32 v241, v241, v35, v36
    v_max3_u32 v241, v241, v37, v38
    v_max3_u32 v241, v241, v39, v40
    v_max3_u32 v241, v241, v41, v42
    v_max3_u32 v241, v241, v43, v44
    v_max3_u32 v241, v241, v45, v46
    v_max3_u32 v241, v241, v47, v48
    v_max3_u32 v241, v241, v49, v50
    v_max3_u32 v241, v241, v51, v52
    v_max3_u32 v241, v241, v53, v54
    v_max3_u32 v241, v241, v55, v56
    v_max3_u32 v241, v241, v57, v58
    v_max3_u32 v241, v241, v59, v60
    v_max3_u32 v241, v241, v61, v62
    v_max_u32 v241, v241, v63
    v_cmp_eq_u32 vcc, -1, v241
    s_cbranch_vccz Lpd_7
    s_mov_b64 exec, vcc
    s_sleep 8
    s_sub_u32 s14, s14, 1
    s_cbranch_scc0 Lpoll_5
    s_or_b32 s15, s15, 2
Lpd_7:
    s_mov_b64 exec, -1
    buffer_load_dword v12, v14, s[52:55], s43 offen sc1
    v_cmp_lt_u32 vcc, 7, v3
    s_waitcnt lgkmcnt(0)
    v_lshlrev_b32 v240, 16, v24
    v_and_b32 v241, 0xffff0000, v24
    v_lshlrev_b32 v242, 16, v25
    v_and_b32 v243, 0xffff0000, v25
    v_add_f32_dpp v244, v240, v240 row_ror:8 row_mask:0xf bank_mask:0xf
    v_add_f32_dpp v245, v241, v241 row_ror:8 row_mask:0xf bank_mask:0xf
    v_add_f32_dpp v246, v242, v242 row_ror:8 row_mask:0xf bank_mask:0xf
    v_add_f32_dpp v247, v243, v243 row_ror:8 row_mask:0xf bank_mask:0xf
    v_cvt_pk_bf16_f32 v24, v244, v245
    v_cvt_pk_bf16_f32 v25, v246, v247
    v_lshlrev_b32 v240, 16, v26
    v_and_b32 v241, 0xffff0000, v26
    v_lshlrev_b32 v242, 16, v27
    v_and_b32 v243, 0xffff0000, v27
    v_add_f32_dpp v244, v240, v240 row_ror:8 row_mask:0xf bank_mask:0xf
    v_add_f32_dpp v245, v241, v241 row_ror:8 row_mask:0xf bank_mask:0xf
    v_add_f32_dpp v246, v242, v242 row_ror:8 row_mask:0xf bank_mask:0xf
    v_add_f32_dpp v247, v243, v243 row_ror:8 row_mask:0xf bank_mask:0xf
    v_cvt_pk_bf16_f32 v26, v244, v245
    v_cvt_pk_bf16_f32 v27, v246, v247
    v_lshlrev_b32 v240, 16, v28
    v_and_b32 v241, 0xffff0000, v28
    v_lshlrev_b32 v242, 16, v29
    v_and_b32 v243, 0xffff0000, v29
    v_add_f32_dpp v244, v240, v240 row_ror:8 row_mask:0xf bank_mask:0xf
    v_add_f32_dpp v245, v241, v241 row_ror:8 row_mask:0xf bank_mask:0xf
    v_add_f32_dpp v246, v242, v242 row_ror:8 row_mask:0xf bank_mask:0xf
    v_add_f32_dpp v247, v243, v243 row_ror:8 row_mask:0xf bank_mask:0xf
    v_cvt_pk_bf16_f32 v28, v244, v245
    v_cvt_pk_bf16_f32 v29, v246, v247
    v_lshlrev_b32 v240, 16, v30
    v_and_b32 v241, 0xffff0000, v30
    v_lshlrev_b32 v242, 16, v31
    v_and_b32 v243, 0xffff0000, v31
    v_add_f32_dpp v244, v240, v240 row_ror:8 row_mask:0xf bank_mask:0xf
    v_add_f32_dpp v245, v241, v241 row_ror:8 row_mask:0xf bank_mask:0xf
    v_add_f32_dpp v246, v242, v242 row_ror:8 row_mask:0xf bank_mask:0xf
    v_add_f32_dpp v247, v243, v243 row_ror:8 row_mask:0xf bank_mask:0xf
    v_cvt_pk_bf16_f32 v30, v244, v245
    v_cvt_pk_bf16_f32 v31, v246, v247
    v_mfma_f32_16x16x32_bf16 v[8:11], v[64:67], v[24:27], 0
    v_mfma_f32_16x16x32_bf16 v[20:23], v[68:71], v[24:27], 0
    v_mfma_f32_16x16x32_bf16 v[248:251], v[72:75], v[24:27], 0
    v_mfma_f32_16x16x32_bf16 v[252:255], v[76:79], v[24:27], 0
    v_lshlrev_b32 v240, 16, v32
    v_and_b32 v241, 0xffff0000, v32
    v_lshlrev_b32 v242, 16, v33
    v_and_b32 v243, 0xffff0000, v33
    v_add_f32_dpp v244, v240, v240 row_ror:8 row_mask:0xf bank_mask:0xf
    v_add_f32_dpp v245, v241, v241 row_ror:8 row_mask:0xf bank_mask:0xf
    v_add_f32_dpp v246, v242, v242 row_ror:8 row_mask:0xf bank_mask:0xf
    v_add_f32_dpp v247, v243, v243 row_ror:8 row_mask:0xf bank_mask:0xf
    v_cvt_pk_bf16_f32 v32, v244, v245
    v_cvt_pk_bf16_f32 v33, v246, v247
    v_lshlrev_b32 v240, 16, v34
    v_and_b32 v241, 0xffff0000, v34
    v_lshlrev_b32 v242, 16, v35
    v_and_b32 v243, 0xffff0000, v35
    v_add_f32_dpp v244, v240, v240 row_ror:8 row_mask:0xf bank_mask:0xf
    v_add_f32_dpp v245, v241, v241 row_ror:8 row_mask:0xf bank_mask:0xf
    v_add_f32_dpp v246, v242, v242 row_ror:8 row_mask:0xf bank_mask:0xf
    v_add_f32_dpp v247, v243, v243 row_ror:8 row_mask:0xf bank_mask:0xf
    v_cvt_pk_bf16_f32 v34, v244, v245
    v_cvt_pk_bf16_f32 v35, v246, v247
    v_mfma_f32_16x16x32_bf16 v[8:11], v[80:83], v[28:31], v[8:11]
    v_mfma_f32_16x16x32_bf16 v[20:23], v[84:87], v[28:31], v[20:23]
    v_mfma_f32_16x16x32_bf16 v[248:251], v[88:91], v[28:31], v[248:251]
    v_mfma_f32_16x16x32_bf16 v[252:255], v[92:95], v[28:31], v[252:255]
    v_lshlrev_b32 v240, 16, v36
    v_and_b32 v241, 0xffff0000, v36
    v_lshlrev_b32 v242, 16, v37
    v_and_b32 v243, 0xffff0000, v37
    v_add_f32_dpp v244, v240, v240 row_ror:8 row_mask:0xf bank_mask:0xf
    v_add_f32_dpp v245, v241, v241 row_ror:8 row_mask:0xf bank_mask:0xf
    v_add_f32_dpp v246, v242, v242 row_ror:8 row_mask:0xf bank_mask:0xf
    v_add_f32_dpp v247, v243, v243 row_ror:8 row_mask:0xf bank_mask:0xf
    v_cvt_pk_bf16_f32 v36, v244, v245
    v_cvt_pk_bf16_f32 v37, v246, v247
    v_lshlrev_b32 v240, 16, v38
    v_and_b32 v241, 0xffff0000, v38
    v_lshlrev_b32 v242, 16, v39
    v_and_b32 v243, 0xffff0000, v39
    v_add_f32_dpp v244, v240, v240 row_ror:8 row_mask:0xf bank_mask:0xf
    v_add_f32_dpp v245, v241, v241 row_ror:8 row_mask:0xf bank_mask:0xf
    v_add_f32_dpp v246, v242, v242 row_ror:8 row_mask:0xf bank_mask:0xf
    v_add_f32_dpp v247, v243, v243 row_ror:8 row_mask:0xf bank_mask:0xf
    v_cvt_pk_bf16_f32 v38, v244, v245
    v_cvt_pk_bf16_f32 v39, v246, v247
    v_mfma_f32_16x16x32_bf16 v[8:11], v[96:99], v[32:35], v[8:11]
    v_mfma_f32_16x16x32_bf16 v[20:23], v[100:103], v[32:35], v[20:23]
    v_mfma_f32_16x16x32_bf16 v[248:251], v[104:107], v[32:35], v[248:251]
    v_mfma_f32_16x16x32_bf16 v[252:255], v[108:111], v[32:35], v[252:255]
    v_lshlrev_b32 v240, 16, v40
    v_and_b32 v241, 0xffff0000, v40
    v_lshlrev_b32 v242, 16, v41
    v_and_b32 v243, 0xffff0000, v41
    v_add_f32_dpp v244, v240, v240 row_ror:8 row_mask:0xf bank_mask:0xf
    v_add_f32_dpp v245, v241, v241 row_ror:8 row_mask:0xf bank_mask:0xf
    v_add_f32_dpp v246, v242, v242 row_ror:8 row_mask:0xf bank_mask:0xf
    v_add_f32_dpp v247, v243, v243 row_ror:8 row_mask:0xf bank_mask:0xf
    v_cvt_pk_bf16_f32 v40, v244, v245
    v_cvt_pk_bf16_f32 v41, v246, v247
    v_lshlrev_b32 v240, 16, v42
    v_and_b32 v241, 0xffff0000, v42
    v_lshlrev_b32 v242, 16, v43
    v_and_b32 v243, 0xffff0000, v43
    v_add_f32_dpp v244, v240, v240 row_ror:8 row_mask:0xf bank_mask:0xf
    v_add_f32_dpp v245, v241, v241 row_ror:8 row_mask:0xf bank_mask:0xf
    v_add_f32_dpp v246, v242, v242 row_ror:8 row_mask:0xf bank_mask:0xf
    v_add_f32_dpp v247, v243, v243 row_ror:8 row_mask:0xf bank_mask:0xf
    v_cvt_pk_bf16_f32 v42, v244, v245
    v_cvt_pk_bf16_f32 v43, v246, v247
    v_mfma_f32_16x16x32_bf16 v[8:11], v[112:115], v[36:39], v[8:11]
    v_mfma_f32_16x16x32_bf16 v[20:23], v[116:119], v[36:39], v[20:23]
    v_mfma_f32_16x16x32_bf16 v[248:251], v[120:123], v[36:39], v[248:251]
    v_mfma_f32_16x16x32_bf16 v[252:255], v[124:127], v[36:39], v[252:255]
    v_lshlrev_b32 v240, 16, v44
    v_and_b32 v241, 0xffff0000, v44
    v_lshlrev_b32 v242, 16, v45
    v_and_b32 v243, 0xffff0000, v45
    v_add_f32_dpp v244, v240, v240 row_ror:8 row_mask:0xf bank_mask:0xf
    v_add_f32_dpp v245, v241, v241 row_ror:8 row_mask:0xf bank_mask:0xf
    v_add_f32_dpp v246, v242, v242 row_ror:8 row_mask:0xf bank_mask:0xf
    v_add_f32_dpp v247, v243, v243 row_ror:8 row_mask:0xf bank_mask:0xf
    v_cvt_pk_bf16_f32 v44, v244, v245
    v_cvt_pk_bf16_f32 v45, v246, v247
    v_lshlrev_b32 v240, 16, v46
    v_and_b32 v241, 0xffff0000, v46
    v_lshlrev_b32 v242, 16, v47
    v_and_b32 v243, 0xffff0000, v47
    v_add_f32_dpp v244, v240, v240 row_ror:8 row_mask:0xf bank_mask:0xf
    v_add_f32_dpp v245, v241, v241 row_ror:8 row_mask:0xf bank_mask:0xf
    v_add_f32_dpp v246, v242, v242 row_ror:8 row_mask:0xf bank_mask:0xf
    v_add_f32_dpp v247, v243, v243 row_ror:8 row_mask:0xf bank_mask:0xf
    v_cvt_pk_bf16_f32 v46, v244, v245
    v_cvt_pk_bf16_f32 v47, v246, v247
    v_mfma_f32_16x16x32_bf16 v[8:11], v[128:131], v[40:43], v[8:11]
    v_mfma_f32_16x16x32_bf16 v[20:23], v[132:135], v[40:43], v[20:23]
    v_mfma_f32_16x16x32_bf16 v[248:251], v[136:139], v[40:43], v[248:251]
    v_mfma_f32_16x16x32_bf16 v[252:255], v[140:143], v[40:43], v[252:255]
    v_lshlrev_b32 v240, 16, v48
    v_and_b32 v241, 0xffff0000, v48
    v_lshlrev_b32 v242, 16, v49
    v_and_b32 v243, 0xffff0000, v49
    v_add_f32_dpp v244, v240, v240 row_ror:8 row_mask:0xf bank_mask:0xf
    v_add_f32_dpp v245, v241, v241 row_ror:8 row_mask:0xf bank_mask:0xf
    v_add_f32_dpp v246, v242, v242 row_ror:8 row_mask:0xf bank_mask:0xf
    v_add_f32_dpp v247, v243, v243 row_ror:8 row_mask:0xf bank_mask:0xf
    v_cvt_pk_bf16_f32 v48, v244, v245
    v_cvt_pk_bf16_f32 v49, v246, v247
    v_lshlrev_b32 v240, 16, v50
    v_and_b32 v241, 0xffff0000, v50
    v_lshlrev_b32 v242, 16, v51
    v_and_b32 v243, 0xffff0000, v51
    v_add_f32_dpp v244, v240, v240 row_ror:8 row_mask:0xf bank_mask:0xf
    v_add_f32_dpp v245, v241, v241 row_ror:8 row_mask:0xf bank_mask:0xf
    v_add_f32_dpp v246, v242, v242 row_ror:8 row_mask:0xf bank_mask:0xf
    v_add_f32_dpp v247, v243, v243 row_ror:8 row_mask:0xf bank_mask:0xf
    v_cvt_pk_bf16_f32 v50, v244, v245
    v_cvt_pk_bf16_f32 v51, v246, v247
    v_mfma_f32_16x16x32_bf16 v[8:11], v[144:147], v[44:47], v[8:11]
    v_mfma_f32_16x16x32_bf16 v[20:23], v[148:151], v[44:47], v[20:23]
    v_mfma_f32_16x16x32_bf16 v[248:251], v[152:155], v[44:47], v[248:251]
    v_mfma_f32_16x16x32_bf16 v[252:255], v[156:159], v[44:47], v[252:255]
    v_lshlrev_b32 v240, 16, v52
    v_and_b32 v241, 0xffff0000, v52
    v_lshlrev_b32 v242, 16, v53
    v_and_b32 v243, 0xffff0000, v53
    v_add_f32_dpp v244, v240, v240 row_ror:8 row_mask:0xf bank_mask:0xf
    v_add_f32_dpp v245, v241, v241 row_ror:8 row_mask:0xf bank_mask:0xf
    v_add_f32_dpp v246, v242, v242 row_ror:8 row_mask:0xf bank_mask:0xf
    v_add_f32_dpp v247, v243, v243 row_ror:8 row_mask:0xf bank_mask:0xf
    v_cvt_pk_bf16_f32 v52, v244, v245
    v_cvt_pk_bf16_f32 v53, v246, v247
    v_lshlrev_b32 v240, 16, v54
    v_and_b32 v241, 0xffff0000, v54
    v_lshlrev_b32 v242, 16, v55
    v_and_b32 v243, 0xffff0000, v55
    v_add_f32_dpp v244, v240, v240 row_ror:8 row_mask:0xf bank_mask:0xf
    v_add_f32_dpp v245, v241, v241 row_ror:8 row_mask:0xf bank_mask:0xf
    v_add_f32_dpp v246, v242, v242 row_ror:8 row_mask:0xf bank_mask:0xf
    v_add_f32_dpp v247, v243, v243 row_ror:8 row_mask:0xf bank_mask:0xf
    v_cvt_pk_bf16_f32 v54, v244, v245
    v_cvt_pk_bf16_f32 v55, v246, v247
    v_mfma_f32_16x16x32_bf16 v[8:11], v[160:163], v[48:51], v[8:11]
    v_mfma_f32_16x16x32_bf16 v[20:23], v[164:167], v[48:51], v[20:23]
    v_mfma_f32_16x16x32_bf16 v[248:251], v[168:171], v[48:51], v[248:251]
    v_mfma_f32_16x16x32_bf16 v[252:255], v[172:175], v[48:51], v[252:255]
    v_lshlrev_b32 v240, 16, v56
    v_and_b32 v241, 0xffff0000, v56
    v_lshlrev_b32 v242, 16, v57
    v_and_b32 v243, 0xffff0000, v57
    v_add_f32_dpp v244, v240, v240 row_ror:8 row_mask:0xf bank_mask:0xf
    v_add_f32_dpp v245, v241, v241 row_ror:8 row_mask:0xf bank_mask:0xf
    v_add_f32_dpp v246, v242, v242 row_ror:8 row_mask:0xf bank_mask:0xf
    v_add_f32_dpp v247, v243, v243 row_ror:8 row_mask:0xf bank_mask:0xf
    v_cvt_pk_bf16_f32 v56, v244, v245
    v_cvt_pk_bf16_f32 v57, v246, v247
    v_lshlrev_b32 v240, 16, v58
    v_and_b32 v241, 0xffff0000, v58
    v_lshlrev_b32 v242, 16, v59
    v_and_b32 v243, 0xffff0000, v59
    v_add_f32_dpp v244, v240, v240 row_ror:8 row_mask:0xf bank_mask:0xf
    v_add_f32_dpp v245, v241, v241 row_ror:8 row_mask:0xf bank_mask:0xf
    v_add_f32_dpp v246, v242, v242 row_ror:8 row_mask:0xf bank_mask:0xf
    v_add_f32_dpp v247, v243, v243 row_ror:8 row_mask:0xf bank_mask:0xf
    v_cvt_pk_bf16_f32 v58, v244, v245
    v_cvt_pk_bf16_f32 v59, v246, v247
    v_mfma_f32_16x16x32_bf16 v[8:11], v[176:179], v[52:55], v[8:11]
    v_mfma_f32_16x16x32_bf16 v[20:23], v[180:183], v[52:55], v[20:23]
    v_mfma_f32_16x16x32_bf16 v[248:251], v[184:187], v[52:55], v[248:251]
    v_mfma_f32_16x16x32_bf16 v[252:255], v[188:191], v[52:55], v[252:255]
    v_lshlrev_b32 v240, 16, v60
    v_and_b32 v241, 0xffff0000, v60
    v_lshlrev_b32 v242, 16, v61
    v_and_b32 v243, 0xffff0000, v61
    v_add_f32_dpp v244, v240, v240 row_ror:8 row_mask:0xf bank_mask:0xf
    v_add_f32_dpp v245, v241, v241 row_ror:8 row_mask:0xf bank_mask:0xf
    v_add_f32_dpp v246, v242, v242 row_ror:8 row_mask:0xf bank_mask:0xf
    v_add_f32_dpp v247, v243, v243 row_ror:8 row_mask:0xf bank_mask:0xf
    v_cvt_pk_bf16_f32 v60, v244, v245
    v_cvt_pk_bf16_f32 v61, v246, v247
    v_lshlrev_b32 v240, 16, v62
    v_and_b32 v241, 0xffff0000, v62
    v_lshlrev_b32 v242, 16, v63
    v_and_b32 v243, 0xffff0000, v63
    v_add_f32_dpp v244, v240, v240 row_ror:8 row_mask:0xf bank_mask:0xf
    v_add_f32_dpp v245, v241, v241 row_ror:8 row_mask:0xf bank_mask:0xf
    v_add_f32_dpp v246, v242, v242 row_ror:8 row_mask:0xf bank_mask:0xf
    v_add_f32_dpp v247, v243, v243 row_ror:8 row_mask:0xf bank_mask:0xf
    v_cvt_pk_bf16_f32 v62, v244, v245
    v_cvt_pk_bf16_f32 v63, v246, v247
    v_mfma_f32_16x16x32_bf16 v[8:11], v[208:211], v[56:59], v[8:11]
    v_mfma_f32_16x16x32_bf16 v[20:23], v[212:215], v[56:59], v[20:23]
    v_mfma_f32_16x16x32_bf16 v[248:251], v[216:219], v[56:59], v[248:251]
    v_mfma_f32_16x16x32_bf16 v[252:255], v[220:223], v[56:59], v[252:255]
    v_mfma_f32_16x16x32_bf16 v[8:11], v[224:227], v[60:63], v[8:11]
    v_mfma_f32_16x16x32_bf16 v[20:23], v[228:231], v[60:63], v[20:23]
    v_mfma_f32_16x16x32_bf16 v[248:251], v[232:235], v[60:63], v[248:251]
    v_mfma_f32_16x16x32_bf16 v[252:255], v[236:239], v[60:63], v[252:255]
    s_nop 5
    v_cndmask_b32 v24, v8, v20, vcc
    v_cndmask_b32 v25, v9, v21, vcc
    v_cndmask_b32 v26, v10, v22, vcc
    v_cndmask_b32 v27, v11, v23, vcc
    v_cndmask_b32 v28, v248, v252, vcc
    v_cndmask_b32 v29, v249, v253, vcc
    v_cndmask_b32 v30, v250, v254, vcc
    v_cndmask_b32 v31, v251, v255, vcc
    ds_write_b128 v196, v[24:27]
    ds_write_b128 v196, v[28:31] offset:128
    ds_read_b128 v[32:35], v197
    ds_read_b128 v[36:39], v197 offset:1024
    s_waitcnt vmcnt(0)
    v_cmp_ne_u32 vcc, s97, v12
    s_cmp_eq_u64 vcc, 0
    s_waitcnt lgkmcnt(0)
    s_cbranch_scc0 Lwt_8
    buffer_store_dwordx4 v[32:35], v198, s[52:55], s11 offen
    buffer_store_dwordx4 v[36:39], v198, s[52:55], s10 offen
    s_mov_b64 exec, 1
    s_waitcnt vmcnt(0)
    buffer_store_dword v1, off, s[52:55], s9
    s_branch Lsd_9
Lwt_8:
    buffer_store_dwordx4 v[32:35], v198, s[52:55], s11 offen sc1
    buffer_store_dwordx4 v[36:39], v198, s[52:55], s10 offen sc1
    s_mov_b64 exec, 1
    s_waitcnt vmcnt(0)
    buffer_store_dword v1, off, s[52:55], s9 sc1
Lsd_9:
    s_mov_b64 exec, -1
    s_branch L_h_getq
L_h_getq0:
    s_waitcnt vmcnt(0) lgkmcnt(0)
    s_cmp_lt_i32 s98, 0
    s_cbranch_scc0 L_h_getq
    s_waitcnt vmcnt(3)
    s_mul_i32 s86, s13, 0
    buffer_load_dwordx4 v[192:195], v5, s[48:51], s86 offen nt
    s_waitcnt vmcnt(3)
    s_mul_i32 s86, s13, 1024
    buffer_load_dwordx4 v[196:199], v5, s[48:51], s86 offen nt
    s_waitcnt vmcnt(3)
    s_mul_i32 s86, s13, 2048
    buffer_load_dwordx4 v[200:203], v5, s[48:51], s86 offen nt
    s_waitcnt vmcnt(3)
    s_mul_i32 s86, s13, 3072
    buffer_load_dwordx4 v[204:207], v5, s[48:51], s86 offen nt
    s_waitcnt vmcnt(3)
    s_mul_i32 s86, s13, 4096
    buffer_load_dwordx4 v[208:211], v5, s[48:51], s86 offen nt
    s_waitcnt vmcnt(3)
    s_mul_i32 s86, s13, 5120
    buffer_load_dwordx4 v[212:215], v5, s[48:51], s86 offen nt
    s_waitcnt vmcnt(3)
    s_mul_i32 s86, s13, 6144
    buffer_load_dwordx4 v[216:219], v5, s[48:51], s86 offen nt
    s_waitcnt vmcnt(3)
    s_mul_i32 s86, s13, 7168
    buffer_load_dwordx4 v[220:223], v5, s[48:51], s86 offen nt
    s_waitcnt vmcnt(3)
    s_mul_i32 s86, s13, 8192
    buffer_load_dwordx4 v[224:227], v5, s[48:51], s86 offen nt
    s_waitcnt vmcnt(3)
    s_mul_i32 s86, s13, 9216
    buffer_load_dwordx4 v[228:231], v5, s[48:51], s86 offen nt
    s_waitcnt vmcnt(3)
    s_mul_i32 s86, s13, 10240
    buffer_load_dwordx4 v[232:235], v5, s[48:51], s86 offen nt
    s_waitcnt vmcnt(3)
    s_mul_i32 s86, s13, 11264
    buffer_load_dwordx4 v[236:239], v5, s[48:51], s86 offen nt
    s_waitcnt vmcnt(3)
    s_mul_i32 s86, s13, 12288
    buffer_load_dwordx4 v[240:243], v5, s[48:51], s86 offen nt
    s_waitcnt vmcnt(3)
    s_mul_i32 s86, s13, 13312
    buffer_load_dwordx4 v[244:247], v5, s[48:51], s86 offen nt
    s_waitcnt vmcnt(3)
    s_mul_i32 s86, s13, 14336
    buffer_load_dwordx4 v[248:251], v5, s[48:51], s86 offen nt
    s_waitcnt vmcnt(3)
    s_mul_i32 s86, s13, 15360
    buffer_load_dwordx4 v[252:255], v5, s[48:51], s86 offen nt
L_h_getq:
    v_lshlrev_b32 v12, 2, v13
    s_and_b32 s9, s5, 3
    s_lshl_b32 s9, s9, 4
    s_add_u32 s9, s9, s43
    s_add_u32 s9, s9, 2048
    buffer_load_dword v45, v14, s[52:55], s43 offen sc1
    s_mov_b32 s14, 400000
Lpoll_10:
    buffer_load_dword v44, v12, s[52:55], s9 offen sc1
    s_waitcnt vmcnt(0)
Lchk_11:
    v_cmp_eq_u32 vcc, -1, v44
    s_cbranch_vccz Lpd_12
    s_mov_b64 exec, vcc
    s_sleep 2
    s_sub_u32 s14, s14, 1
    s_cbranch_scc0 Lpoll_10
    s_or_b32 s15, s15, 4
Lpd_12:
    s_mov_b64 exec, -1
    v_lshlrev_b32 v12, 3, v1
    s_lshl_b32 s8, s87, 10
    s_add_u32 s8, s8, 0x100000
    buffer_load_dwordx2 v[40:41], v12, s[52:55], s8 offen sc1
    buffer_load_dwordx2 v[42:43], v12, s[52:55], s8 offen offset:512 sc1
    v_mov_b32 v46, s97
    v_mov_b32 v48, -1
    v_mov_b32 v49, -1
    v_mov_b32 v50, -1
    v_mov_b32 v51, -1
    v_cmp_ne_u32 vcc, s97, v45
    s_cmp_eq_u64 vcc, 0
    s_cbranch_scc0 L_h_cw
    s_lshl_b32 s8, s87, 8
    s_add_u32 s8, s8, 0x30000
    s_mov_b64 exec, 0xffff
    buffer_store_dwordx4 v[48:51], v5, s[52:55], s8 offen
    s_cmp_eq_u32 s100, 2
    s_cbranch_scc0 L_h_nxa
    s_lshl_b32 s8, s98, 9
    s_add_u32 s8, s8, s90
    s_mov_b32 exec_lo, -1
    buffer_store_dwordx4 v[48:51], v5, s[52:55], s8 offen
L_h_nxa:
    s_lshl_b32 s8, s87, 2
    s_add_u32 s8, s8, 62464
    s_mov_b64 exec, 1
    s_waitcnt vmcnt(0)
    buffer_store_dword v46, off, s[52:55], s8
    s_mov_b64 exec, -1
    s_branch L_h_cd
L_h_cw:
    s_lshl_b32 s8, s87, 8
    s_add_u32 s8, s8, 0x30000
    s_mov_b64 exec, 0xffff
    buffer_store_dwordx4 v[48:51], v5, s[52:55], s8 offen sc1
    s_cmp_eq_u32 s100, 2
    s_cbranch_scc0 L_h_nxb
    s_lshl_b32 s8, s98, 9
    s_add_u32 s8, s8, s90
    s_mov_b32 exec_lo, -1
    buffer_store_dwordx4 v[48:51], v5, s[52:55], s8 offen sc1
L_h_nxb:
    s_lshl_b32 s8, s87, 2
    s_add_u32 s8, s8, 62464
    s_mov_b64 exec, 1
    s_waitcnt vmcnt(0)
    buffer_store_dword v46, off, s[52:55], s8 sc1
    s_mov_b64 exec, -1
L_h_cd:
    v_add_f32 v32, v40, v42
    v_add_f32 v33, v41, v43
    v_cvt_pk_bf16_f32 v32, v32, v33
    ds_write_b32 v6, v32 offset:0
    s_waitcnt lgkmcnt(0)
    ds_write_b32 v15, v15
    s_setprio 0
    s_cmp_lt_i32 s98, 0
    s_cbranch_scc1 L_h_nv
    s_waitcnt vmcnt(11)
    s_mul_i32 s86, s13, 0
    buffer_load_dwordx4 v[192:195], v5, s[48:51], s86 offen nt
    s_waitcnt vmcnt(11)
    s_mul_i32 s86, s13, 1024
    buffer_load_dwordx4 v[196:199], v5, s[48:51], s86 offen nt
    s_waitcnt vmcnt(11)
    s_mul_i32 s86, s13, 2048
    buffer_load_dwordx4 v[200:203], v5, s[48:51], s86 offen nt
    s_waitcnt vmcnt(11)
    s_mul_i32 s86, s13, 3072
    buffer_load_dwordx4 v[204:207], v5, s[48:51], s86 offen nt
    s_waitcnt vmcnt(11)
    s_mul_i32 s86, s13, 4096
    buffer_load_dwordx4 v[208:211], v5, s[48:51], s86 offen nt
    s_waitcnt vmcnt(11)
    s_mul_i32 s86, s13, 5120
    buffer_load_dwordx4 v[212:215], v5, s[48:51], s86 offen nt
    s_waitcnt vmcnt(11)
    s_mul_i32 s86, s13, 6144
    buffer_load_dwordx4 v[216:219], v5, s[48:51], s86 offen nt
    s_waitcnt vmcnt(11)
    s_mul_i32 s86, s13, 7168
    buffer_load_dwordx4 v[220:223], v5, s[48:51], s86 offen nt
    s_waitcnt vmcnt(11)
    s_mul_i32 s86, s13, 8192
    buffer_load_dwordx4 v[224:227], v5, s[48:51], s86 offen nt
    s_waitcnt vmcnt(11)
    s_mul_i32 s86, s13, 9216
    buffer_load_dwordx4 v[228:231], v5, s[48:51], s86 offen nt
    s_waitcnt vmcnt(11)
    s_mul_i32 s86, s13, 10240
    buffer_load_dwordx4 v[232:235], v5, s[48:51], s86 offen nt
    s_waitcnt vmcnt(11)
    s_mul_i32 s86, s13, 11264
    buffer_load_dwordx4 v[236:239], v5, s[48:51], s86 offen nt
    s_waitcnt vmcnt(11)
    s_mul_i32 s86, s13, 12288
    buffer_load_dwordx4 v[240:243], v5, s[48:51], s86 offen nt
    s_waitcnt vmcnt(11)
    s_mul_i32 s86, s13, 13312
    buffer_load_dwordx4 v[244:247], v5, s[48:51], s86 offen nt
    s_waitcnt vmcnt(11)
    s_mul_i32 s86, s13, 14336
    buffer_load_dwordx4 v[248:251], v5, s[48:51], s86 offen nt
    s_waitcnt vmcnt(11)
    s_mul_i32 s86, s13, 15360
    buffer_load_dwordx4 v[252:255], v5, s[48:51], s86 offen nt
L_h_nv:
    s_cmp_eq_u32 s100, 1
    s_cbranch_scc0 L_h_ncs
    s_mov_b32 m0, 136192
    s_mov_b32 s8, 30720
L_h_cs:
    buffer_load_dwordx4 v5, s[52:55], s8 offen sc1 lds
    s_add_u32 m0, m0, 1024
    s_add_u32 s8, s8, 1024
    s_cmp_lt_u32 s8, 51200
    s_cbranch_scc1 L_h_cs
L_h_ncs:
    s_getpc_b64 s[8:9]
L_pc:
    s_add_u32 s8, s8, L_tail - L_pc
    s_addc_u32 s9, s9, 0
    v_lshlrev_b32 v8, 7, v1
    v_min_u32 v8, L_end - L_tail, v8
    v_mov_b32 v9, s9
    v_add_co_u32 v8, vcc, s8, v8
    s_nop 1
    v_addc_co_u32 v9, vcc, 0, v9, vcc
    global_load_dword v23, v[8:9], off
    s_mov_b32 s14, 3200000
Lsp_13:
    ds_read_b32 v12, v15 offset:8
    s_waitcnt lgkmcnt(0)
    v_readfirstlane_b32 s8, v12
    s_nop 0
    s_cmp_ge_u32 s8, 7
    s_cbranch_scc1 Lspd_14
    s_sleep 1
    s_sub_u32 s14, s14, 1
    s_cbranch_scc0 Lsp_13
    s_or_b32 s15, s15, 2048
Lspd_14:
    v_add_u32 v8, 62464, v5
    ds_read_b128 v[64:67], v8 offset:0
    ds_read_b128 v[68:71], v8 offset:1024
    ds_read_b128 v[72:75], v8 offset:2048
    ds_read_b128 v[76:79], v8 offset:3072
    ds_read_b128 v[80:83], v8 offset:4096
    ds_read_b128 v[84:87], v8 offset:5120
    ds_read_b128 v[88:91], v8 offset:6144
    ds_read_b128 v[92:95], v8 offset:7168
    ds_read_b128 v[96:99], v8 offset:8192
    ds_read_b128 v[100:103], v8 offset:9216
    ds_read_b128 v[104:107], v8 offset:10240
    ds_read_b128 v[108:111], v8 offset:11264
    ds_read_b128 v[112:115], v8 offset:12288
    ds_read_b128 v[116:119], v8 offset:13312
    ds_read_b128 v[120:123], v8 offset:14336
    ds_read_b128 v[124:127], v8 offset:15360
    ds_read_b128 v[128:131], v8 offset:16384
    ds_read_b128 v[132:135], v8 offset:17408
    ds_read_b128 v[136:139], v8 offset:18432
    ds_read_b128 v[140:143], v8 offset:19456
    ds_read_b128 v[144:147], v8 offset:20480
    ds_read_b128 v[148:151], v8 offset:21504
    ds_read_b128 v[152:155], v8 offset:22528
    ds_read_b128 v[156:159], v8 offset:23552
    ds_read_b128 v[160:163], v8 offset:24576
    ds_read_b128 v[164:167], v8 offset:25600
    ds_read_b128 v[168:171], v8 offset:26624
    ds_read_b128 v[172:175], v8 offset:27648
    ds_read_b128 v[176:179], v8 offset:28672
    ds_read_b128 v[180:183], v8 offset:29696
    ds_read_b128 v[184:187], v8 offset:30720
    ds_read_b128 v[188:191], v8 offset:31744
L_qk:
    v_lshlrev_b32 v8, 6, v13
    v_lshl_add_u32 v8, v2, 4, v8
    ds_read_b128 v[24:27], v8 offset:0
    v_lshrrev_b32 v9, 2, v3
    s_waitcnt lgkmcnt(0)
    v_cmp_eq_u32 vcc, 0, v9
    s_nop 1
    v_cndmask_b32 v32, 0, v24, vcc
    v_cndmask_b32 v33, 0, v25, vcc
    v_cndmask_b32 v34, 0, v26, vcc
    v_cndmask_b32 v35, 0, v27, vcc
    v_cmp_eq_u32 vcc, 1, v9
    s_nop 1
    v_cndmask_b32 v36, 0, v24, vcc
    v_cndmask_b32 v37, 0, v25, vcc
    v_cndmask_b32 v38, 0, v26, vcc
    v_cndmask_b32 v39, 0, v27, vcc
    v_cmp_eq_u32 vcc, 2, v9
    s_nop 1
    v_cndmask_b32 v40, 0, v24, vcc
    v_cndmask_b32 v41, 0, v25, vcc
    v_cndmask_b32 v42, 0, v26, vcc
    v_cndmask_b32 v43, 0, v27, vcc
    v_cmp_eq_u32 vcc, 3, v9
    s_nop 1
    v_cndmask_b32 v44, 0, v24, vcc
    v_cndmask_b32 v45, 0, v25, vcc
    v_cndmask_b32 v46, 0, v26, vcc
    v_cndmask_b32 v47, 0, v27, vcc
    s_waitcnt vmcnt(16)
    s_nop 0
    v_mfma_f32_16x16x32_bf16 v[48:51], v[64:67], v[32:35], 0
    v_mfma_f32_16x16x32_bf16 v[48:51], v[68:71], v[36:39], v[48:51]
    v_mfma_f32_16x16x32_bf16 v[48:51], v[72:75], v[40:43], v[48:51]
    v_mfma_f32_16x16x32_bf16 v[48:51], v[76:79], v[44:47], v[48:51]
    v_mfma_f32_16x16x32_bf16 v[52:55], v[80:83], v[32:35], 0
    v_mfma_f32_16x16x32_bf16 v[52:55], v[84:87], v[36:39], v[52:55]
    v_mfma_f32_16x16x32_bf16 v[52:55], v[88:91], v[40:43], v[52:55]
    v_mfma_f32_16x16x32_bf16 v[52:55], v[92:95], v[44:47], v[52:55]
    v_mfma_f32_16x16x32_bf16 v[56:59], v[96:99], v[32:35], 0
    v_mfma_f32_16x16x32_bf16 v[56:59], v[100:103], v[36:39], v[56:59]
    v_mfma_f32_16x16x32_bf16 v[56:59], v[104:107], v[40:43], v[56:59]
    v_mfma_f32_16x16x32_bf16 v[56:59], v[108:111], v[44:47], v[56:59]
    v_mfma_f32_16x16x32_bf16 v[60:63], v[112:115], v[32:35], 0
    v_mfma_f32_16x16x32_bf16 v[60:63], v[116:119], v[36:39], v[60:63]
    v_mfma_f32_16x16x32_bf16 v[60:63], v[120:123], v[40:43], v[60:63]
    v_mfma_f32_16x16x32_bf16 v[60:63], v[124:127], v[44:47], v[60:63]
    s_mul_i32 s86, s13, 16384
    buffer_load_dwordx4 v[64:67], v5, s[48:51], s86 offen nt
    s_mul_i32 s86, s13, 17408
    buffer_load_dwordx4 v[68:71], v5, s[48:51], s86 offen nt
    s_mul_i32 s86, s13, 18432
    buffer_load_dwordx4 v[72:75], v5, s[48:51], s86 offen nt
    s_mul_i32 s86, s13, 19456
    buffer_load_dwordx4 v[76:79], v5, s[48:51], s86 offen nt
    s_nop 7
    v_mov_b32_dpp v24, v48 quad_perm:[0,0,0,0] row_mask:0xf bank_mask:0xf
    v_mov_b32_dpp v25, v52 quad_perm:[0,0,0,0] row_mask:0xf bank_mask:0xf
    v_mov_b32_dpp v26, v56 quad_perm:[0,0,0,0] row_mask:0xf bank_mask:0xf
    v_mov_b32_dpp v27, v60 quad_perm:[0,0,0,0] row_mask:0xf bank_mask:0xf
    v_add_f32_dpp v24, v49, v24 quad_perm:[1,1,1,1] row_mask:0xf bank_mask:0xf
    v_add_f32_dpp v25, v53, v25 quad_perm:[1,1,1,1] row_mask:0xf bank_mask:0xf
    v_add_f32_dpp v26, v57, v26 quad_perm:[1,1,1,1] row_mask:0xf bank_mask:0xf
    v_add_f32_dpp v27, v61, v27 quad_perm:[1,1,1,1] row_mask:0xf bank_mask:0xf
    v_add_f32_dpp v24, v50, v24 quad_perm:[2,2,2,2] row_mask:0xf bank_mask:0xf
    v_add_f32_dpp v25, v54, v25 quad_perm:[2,2,2,2] row_mask:0xf bank_mask:0xf
    v_add_f32_dpp v26, v58, v26 quad_perm:[2,2,2,2] row_mask:0xf bank_mask:0xf
    v_add_f32_dpp v27, v62, v27 quad_perm:[2,2,2,2] row_mask:0xf bank_mask:0xf
    v_add_f32_dpp v24, v51, v24 quad_perm:[3,3,3,3] row_mask:0xf bank_mask:0xf
    v_add_f32_dpp v25, v55, v25 quad_perm:[3,3,3,3] row_mask:0xf bank_mask:0xf
    v_add_f32_dpp v26, v59, v26 quad_perm:[3,3,3,3] row_mask:0xf bank_mask:0xf
    v_add_f32_dpp v27, v63, v27 quad_perm:[3,3,3,3] row_mask:0xf bank_mask:0xf
    s_nop 1
    v_mfma_f32_16x16x32_bf16 v[48:51], v[128:131], v[32:35], 0
    v_mfma_f32_16x16x32_bf16 v[48:51], v[132:135], v[36:39], v[48:51]
    v_mfma_f32_16x16x32_bf16 v[48:51], v[136:139], v[40:43], v[48:51]
    v_mfma_f32_16x16x32_bf16 v[48:51], v[140:143], v[44:47], v[48:51]
    v_mfma_f32_16x16x32_bf16 v[52:55], v[144:147], v[32:35], 0
    v_mfma_f32_16x16x32_bf16 v[52:55], v[148:151], v[36:39], v[52:55]
    v_mfma_f32_16x16x32_bf16 v[52:55], v[152:155], v[40:43], v[52:55]
    v_mfma_f32_16x16x32_bf16 v[52:55], v[156:159], v[44:47], v[52:55]
    v_mfma_f32_16x16x32_bf16 v[56:59], v[160:163], v[32:35], 0
    v_mfma_f32_16x16x32_bf16 v[56:59], v[164:167], v[36:39], v[56:59]
    v_mfma_f32_16x16x32_bf16 v[56:59], v[168:171], v[40:43], v[56:59]
    v_mfma_f32_16x16x32_bf16 v[56:59], v[172:175], v[44:47], v[56:59]
    v_mfma_f32_16x16x32_bf16 v[60:63], v[176:179], v[32:35], 0
    v_mfma_f32_16x16x32_bf16 v[60:63], v[180:183], v[36:39], v[60:63]
    v_mfma_f32_16x16x32_bf16 v[60:63], v[184:187], v[40:43], v[60:63]
    v_mfma_f32_16x16x32_bf16 v[60:63], v[188:191], v[44:47], v[60:63]
    s_nop 7
    v_mov_b32_dpp v28, v48 quad_perm:[0,0,0,0] row_mask:0xf bank_mask:0xf
    v_mov_b32_dpp v29, v52 quad_perm:[0,0,0,0] row_mask:0xf bank_mask:0xf
    v_mov_b32_dpp v30, v56 quad_perm:[0,0,0,0] row_mask:0xf bank_mask:0xf
    v_mov_b32_dpp v31, v60 quad_perm:[0,0,0,0] row_mask:0xf bank_mask:0xf
    v_add_f32_dpp v28, v49, v28 quad_perm:[1,1,1,1] row_mask:0xf bank_mask:0xf
    v_add_f32_dpp v29, v53, v29 quad_perm:[1,1,1,1] row_mask:0xf bank_mask:0xf
    v_add_f32_dpp v30, v57, v30 quad_perm:[1,1,1,1] row_mask:0xf bank_mask:0xf
    v_add_f32_dpp v31, v61, v31 quad_perm:[1,1,1,1] row_mask:0xf bank_mask:0xf
    v_add_f32_dpp v28, v50, v28 quad_perm:[2,2,2,2] row_mask:0xf bank_mask:0xf
    v_add_f32_dpp v29, v54, v29 quad_perm:[2,2,2,2] row_mask:0xf bank_mask:0xf
    v_add_f32_dpp v30, v58, v30 quad_perm:[2,2,2,2] row_mask:0xf bank_mask:0xf
    v_add_f32_dpp v31, v62, v31 quad_perm:[2,2,2,2] row_mask:0xf bank_mask:0xf
    v_add_f32_dpp v28, v51, v28 quad_perm:[3,3,3,3] row_mask:0xf bank_mask:0xf
    v_add_f32_dpp v29, v55, v29 quad_perm:[3,3,3,3] row_mask:0xf bank_mask:0xf
    v_add_f32_dpp v30, v59, v30 quad_perm:[3,3,3,3] row_mask:0xf bank_mask:0xf
    v_add_f32_dpp v31, v63, v31 quad_perm:[3,3,3,3] row_mask:0xf bank_mask:0xf
    s_nop 1
    s_mov_b32 s8, 0x3db504f3
    v_cvt_pk_bf16_f32 v8, v24, v25
    v_lshlrev_b32 v24, 16, v8
    v_and_b32 v25, 0xffff0000, v8
    v_mul_f32 v24, s8, v24
    v_mul_f32 v25, s8, v25
    v_cvt_pk_bf16_f32 v8, v24, v25
    v_lshlrev_b32 v24, 16, v8
    v_and_b32 v25, 0xffff0000, v8
    v_cvt_pk_bf16_f32 v8, v26, v27
    v_lshlrev_b32 v26, 16, v8
    v_and_b32 v27, 0xffff0000, v8
    v_mul_f32 v26, s8, v26
    v_mul_f32 v27, s8, v27
    v_cvt_pk_bf16_f32 v8, v26, v27
    v_lshlrev_b32 v26, 16, v8
    v_and_b32 v27, 0xffff0000, v8
    v_cvt_pk_bf16_f32 v8, v28, v29
    v_lshlrev_b32 v28, 16, v8
    v_and_b32 v29, 0xffff0000, v8
    v_mul_f32 v28, s8, v28
    v_mul_f32 v29, s8, v29
    v_cvt_pk_bf16_f32 v8, v28, v29
    v_lshlrev_b32 v28, 16, v8
    v_and_b32 v29, 0xffff0000, v8
    v_cvt_pk_bf16_f32 v8, v30, v31
    v_lshlrev_b32 v30, 16, v8
    v_and_b32 v31, 0xffff0000, v8
    v_mul_f32 v30, s8, v30
    v_mul_f32 v31, s8, v31
    v_cvt_pk_bf16_f32 v8, v30, v31
    v_lshlrev_b32 v30, 16, v8
    v_and_b32 v31, 0xffff0000, v8
    v_max3_f32 v8, v24, v25, v26
    v_max3_f32 v8, v8, v27, v28
    v_max3_f32 v8, v8, v29, v30
    v_max_f32 v8, v8, v31
    s_nop 1
    v_max_f32_dpp v8, v8, v8 row_ror:4 row_mask:0xf bank_mask:0xf
    s_nop 1
    v_max_f32_dpp v8, v8, v8 row_ror:8 row_mask:0xf bank_mask:0xf
    s_nop 1
    v_max_f32_dpp v8, v8, v8 row_bcast:15 row_mask:0xa bank_mask:0xf
    s_nop 1
    v_max_f32_dpp v8, v8, v8 row_bcast:31 row_mask:0xc bank_mask:0xf
    s_nop 1
    v_readlane_b32 s95, v8, 63
    s_mov_b32 s8, 0x3fb8aa3b
    s_nop 1
    v_subrev_f32 v24, s95, v24
    v_subrev_f32 v25, s95, v25
    v_subrev_f32 v26, s95, v26
    v_subrev_f32 v27, s95, v27
    v_subrev_f32 v28, s95, v28
    v_subrev_f32 v29, s95, v29
    v_subrev_f32 v30, s95, v30
    v_subrev_f32 v31, s95, v31
    v_mul_f32 v24, s8, v24
    v_mul_f32 v25, s8, v25
    v_mul_f32 v26, s8, v26
    v_mul_f32 v27, s8, v27
    v_mul_f32 v28, s8, v28
    v_mul_f32 v29, s8, v29
    v_mul_f32 v30, s8, v30
    v_mul_f32 v31, s8, v31
    v_exp_f32 v24, v24
    v_exp_f32 v25, v25
    v_exp_f32 v26, v26
    v_exp_f32 v27, v27
    v_exp_f32 v28, v28
    v_exp_f32 v29, v29
    v_exp_f32 v30, v30
    v_exp_f32 v31, v31
    s_nop 0
    v_add_f32 v8, v24, v25
    v_add_f32 v9, v26, v27
    v_add_f32 v10, v28, v29
    v_add_f32 v11, v30, v31
    v_add_f32 v8, v8, v9
    v_add_f32 v10, v10, v11
    v_add_f32 v8, v8, v10
    s_nop 1
    v_add_f32_dpp v8, v8, v8 row_ror:4 row_mask:0xf bank_mask:0xf
    s_nop 1
    v_add_f32_dpp v8, v8, v8 row_ror:8 row_mask:0xf bank_mask:0xf
    s_nop 1
    v_add_f32_dpp v8, v8, v8 row_bcast:15 row_mask:0xa bank_mask:0xf
    s_nop 1
    v_add_f32_dpp v8, v8, v8 row_bcast:31 row_mask:0xc bank_mask:0xf
    s_nop 1
    v_readlane_b32 s10, v8, 63
    s_lshl_b32 s11, s3, 3
    v_mov_b32 v10, s95
    v_mov_b32 v9, s11
    v_mov_b32 v11, s10
    ds_write_b64 v9, v[10:11] offset:256
    s_waitcnt lgkmcnt(0)
    v_mov_b32 v12, 1
    s_mov_b64 exec, 1
    ds_add_u32 v15, v12 offset:12
    s_mov_b64 exec, -1
    s_waitcnt vmcnt(7)
    s_mul_i32 s86, s13, 20480
    buffer_load_dwordx4 v[80:83], v5, s[48:51], s86 offen nt
    v_and_b32 v146, 7, v1
    v_and_b32 v147, 1, v2
    v_lshlrev_b32 v147, 2, v147
    v_lshl_add_u32 v148, v146, 3, v147
    v_lshl_add_u32 v149, v146, 6, v147
    v_and_b32 v129, 31, v1
    v_lshlrev_b32 v129, 2, v129
    s_lshl_b32 s10, s4, 7
    s_add_u32 s10, s10, 62464
    buffer_load_dword v132, v129, s[52:55], s10 offen sc1
    buffer_load_dword v128, off, s[80:83], 0 offset:128 sc1
    s_waitcnt vmcnt(9)
    s_mul_i32 s86, s13, 21504
    buffer_load_dwordx4 v[84:87], v5, s[48:51], s86 offen nt
    s_waitcnt vmcnt(9)
    s_mul_i32 s86, s13, 22528
    buffer_load_dwordx4 v[88:91], v5, s[48:51], s86 offen nt
    s_waitcnt vmcnt(9)
    s_mul_i32 s86, s13, 23552
    buffer_load_dwordx4 v[92:95], v5, s[48:51], s86 offen nt
    s_waitcnt vmcnt(9)
    s_mul_i32 s86, s13, 24576
    buffer_load_dwordx4 v[96:99], v5, s[48:51], s86 offen nt
    s_waitcnt vmcnt(9)
    s_mul_i32 s86, s13, 25600
    buffer_load_dwordx4 v[100:103], v5, s[48:51], s86 offen nt
    s_waitcnt vmcnt(9)
    s_mul_i32 s86, s13, 26624
    buffer_load_dwordx4 v[104:107], v5, s[48:51], s86 offen nt
    s_mov_b32 s14, 3200000
Lsp_15:
    ds_read_b32 v12, v15 offset:12
    s_waitcnt lgkmcnt(0)
    v_readfirstlane_b32 s8, v12
    s_nop 0
    s_cmp_ge_u32 s8, 8
    s_cbranch_scc1 Lspd_16
    s_sleep 1
    s_sub_u32 s14, s14, 1
    s_cbranch_scc0 Lsp_15
    s_or_b32 s15, s15, 4096
Lspd_16:
    v_and_b32 v9, 7, v1
    v_lshlrev_b32 v9, 3, v9
    s_mov_b32 s8, 0x3fb8aa3b
    ds_read_b64 v[10:11], v9 offset:256
    s_waitcnt lgkmcnt(0)
    v_max_f32_dpp v8, v10, v10 row_ror:4 row_mask:0xf bank_mask:0xf
    s_nop 1
    v_max_f32_dpp v8, v8, v8 row_ror:2 row_mask:0xf bank_mask:0xf
    s_nop 1
    v_max_f32_dpp v8, v8, v8 row_ror:1 row_mask:0xf bank_mask:0xf
    v_sub_f32 v10, v10, v8
    v_sub_f32 v12, s95, v8
    v_mul_f32 v10, s8, v10
    v_mul_f32 v12, s8, v12
    v_exp_f32 v10, v10
    v_exp_f32 v12, v12
    s_nop 0
    v_mul_f32 v10, v10, v11
    s_nop 1
    v_add_f32_dpp v10, v10, v10 quad_perm:[1,0,3,2] row_mask:0xf bank_mask:0xf
    s_nop 1
    v_add_f32_dpp v10, v10, v10 quad_perm:[2,3,0,1] row_mask:0xf bank_mask:0xf
    s_nop 1
    v_add_f32_dpp v10, v10, v10 row_half_mirror row_mask:0xf bank_mask:0xf
    v_rcp_f32 v10, v10
    s_nop 0
    v_mul_f32 v10, v10, v12
    v_mul_f32 v24, v10, v24
    v_mul_f32 v25, v10, v25
    v_mul_f32 v26, v10, v26
    v_mul_f32 v27, v10, v27
    v_mul_f32 v28, v10, v28
    v_mul_f32 v29, v10, v29
    v_mul_f32 v30, v10, v30
    v_mul_f32 v31, v10, v31
    v_cvt_pk_bf16_f32 v24, v24, v24
    v_cvt_pk_bf16_f32 v25, v25, v25
    v_cvt_pk_bf16_f32 v26, v26, v26
    v_cvt_pk_bf16_f32 v27, v27, v27
    v_cvt_pk_bf16_f32 v28, v28, v28
    v_cvt_pk_bf16_f32 v29, v29, v29
    v_cvt_pk_bf16_f32 v30, v30, v30
    v_cvt_pk_bf16_f32 v31, v31, v31
    s_nop 1
    v_and_b32_dpp v32, v24, v16 row_newbcast:0 row_mask:0xf bank_mask:0xf
    v_and_b32_dpp v33, v24, v17 row_newbcast:0 row_mask:0xf bank_mask:0xf
    v_and_b32_dpp v34, v24, v18 row_newbcast:0 row_mask:0xf bank_mask:0xf
    v_and_b32_dpp v35, v24, v19 row_newbcast:0 row_mask:0xf bank_mask:0xf
    v_and_b32_dpp v36, v24, v16 row_newbcast:4 row_mask:0xf bank_mask:0xf
    v_and_b32_dpp v37, v24, v17 row_newbcast:4 row_mask:0xf bank_mask:0xf
    v_and_b32_dpp v38, v24, v18 row_newbcast:4 row_mask:0xf bank_mask:0xf
    v_and_b32_dpp v39, v24, v19 row_newbcast:4 row_mask:0xf bank_mask:0xf
    v_mfma_f32_16x16x32_bf16 v[20:23], v[32:35], v[192:195], 0
    v_and_b32_dpp v32, v24, v16 row_newbcast:8 row_mask:0xf bank_mask:0xf
    v_and_b32_dpp v33, v24, v17 row_newbcast:8 row_mask:0xf bank_mask:0xf
    v_and_b32_dpp v34, v24, v18 row_newbcast:8 row_mask:0xf bank_mask:0xf
    v_and_b32_dpp v35, v24, v19 row_newbcast:8 row_mask:0xf bank_mask:0xf
    v_mfma_f32_16x16x32_bf16 v[20:23], v[36:39], v[196:199], v[20:23]
    v_and_b32_dpp v36, v24, v16 row_newbcast:12 row_mask:0xf bank_mask:0xf
    v_and_b32_dpp v37, v24, v17 row_newbcast:12 row_mask:0xf bank_mask:0xf
    v_and_b32_dpp v38, v24, v18 row_newbcast:12 row_mask:0xf bank_mask:0xf
    v_and_b32_dpp v39, v24, v19 row_newbcast:12 row_mask:0xf bank_mask:0xf
    v_mfma_f32_16x16x32_bf16 v[20:23], v[32:35], v[200:203], v[20:23]
    v_and_b32_dpp v32, v25, v16 row_newbcast:0 row_mask:0xf bank_mask:0xf
    v_and_b32_dpp v33, v25, v17 row_newbcast:0 row_mask:0xf bank_mask:0xf
    v_and_b32_dpp v34, v25, v18 row_newbcast:0 row_mask:0xf bank_mask:0xf
    v_and_b32_dpp v35, v25, v19 row_newbcast:0 row_mask:0xf bank_mask:0xf
    v_mfma_f32_16x16x32_bf16 v[20:23], v[36:39], v[204:207], v[20:23]
    v_and_b32_dpp v36, v25, v16 row_newbcast:4 row_mask:0xf bank_mask:0xf
    v_and_b32_dpp v37, v25, v17 row_newbcast:4 row_mask:0xf bank_mask:0xf
    v_and_b32_dpp v38, v25, v18 row_newbcast:4 row_mask:0xf bank_mask:0xf
    v_and_b32_dpp v39, v25, v19 row_newbcast:4 row_mask:0xf bank_mask:0xf
    v_mfma_f32_16x16x32_bf16 v[20:23], v[32:35], v[208:211], v[20:23]
    v_and_b32_dpp v32, v25, v16 row_newbcast:8 row_mask:0xf bank_mask:0xf
    v_and_b32_dpp v33, v25, v17 row_newbcast:8 row_mask:0xf bank_mask:0xf
    v_and_b32_dpp v34, v25, v18 row_newbcast:8 row_mask:0xf bank_mask:0xf
    v_and_b32_dpp v35, v25, v19 row_newbcast:8 row_mask:0xf bank_mask:0xf
    v_mfma_f32_16x16x32_bf16 v[20:23], v[36:39], v[212:215], v[20:23]
    v_and_b32_dpp v36, v25, v16 row_newbcast:12 row_mask:0xf bank_mask:0xf
    v_and_b32_dpp v37, v25, v17 row_newbcast:12 row_mask:0xf bank_mask:0xf
    v_and_b32_dpp v38, v25, v18 row_newbcast:12 row_mask:0xf bank_mask:0xf
    v_and_b32_dpp v39, v25, v19 row_newbcast:12 row_mask:0xf bank_mask:0xf
    v_mfma_f32_16x16x32_bf16 v[20:23], v[32:35], v[216:219], v[20:23]
    v_and_b32_dpp v32, v26, v16 row_newbcast:0 row_mask:0xf bank_mask:0xf
    v_and_b32_dpp v33, v26, v17 row_newbcast:0 row_mask:0xf bank_mask:0xf
    v_and_b32_dpp v34, v26, v18 row_newbcast:0 row_mask:0xf bank_mask:0xf
    v_and_b32_dpp v35, v26, v19 row_newbcast:0 row_mask:0xf bank_mask:0xf
    v_mfma_f32_16x16x32_bf16 v[20:23], v[36:39], v[220:223], v[20:23]
    v_and_b32_dpp v36, v26, v16 row_newbcast:4 row_mask:0xf bank_mask:0xf
    v_and_b32_dpp v37, v26, v17 row_newbcast:4 row_mask:0xf bank_mask:0xf
    v_and_b32_dpp v38, v26, v18 row_newbcast:4 row_mask:0xf bank_mask:0xf
    v_and_b32_dpp v39, v26, v19 row_newbcast:4 row_mask:0xf bank_mask:0xf
    v_mfma_f32_16x16x32_bf16 v[20:23], v[32:35], v[224:227], v[20:23]
    v_and_b32_dpp v32, v26, v16 row_newbcast:8 row_mask:0xf bank_mask:0xf
    v_and_b32_dpp v33, v26, v17 row_newbcast:8 row_mask:0xf bank_mask:0xf
    v_and_b32_dpp v34, v26, v18 row_newbcast:8 row_mask:0xf bank_mask:0xf
    v_and_b32_dpp v35, v26, v19 row_newbcast:8 row_mask:0xf bank_mask:0xf
    v_mfma_f32_16x16x32_bf16 v[20:23], v[36:39], v[228:231], v[20:23]
    v_and_b32_dpp v36, v26, v16 row_newbcast:12 row_mask:0xf bank_mask:0xf
    v_and_b32_dpp v37, v26, v17 row_newbcast:12 row_mask:0xf bank_mask:0xf
    v_and_b32_dpp v38, v26, v18 row_newbcast:12 row_mask:0xf bank_mask:0xf
    v_and_b32_dpp v39, v26, v19 row_newbcast:12 row_mask:0xf bank_mask:0xf
    v_mfma_f32_16x16x32_bf16 v[20:23], v[32:35], v[232:235], v[20:23]
    v_and_b32_dpp v32, v27, v16 row_newbcast:0 row_mask:0xf bank_mask:0xf
    v_and_b32_dpp v33, v27, v17 row_newbcast:0 row_mask:0xf bank_mask:0xf
    v_and_b32_dpp v34, v27, v18 row_newbcast:0 row_mask:0xf bank_mask:0xf
    v_and_b32_dpp v35, v27, v19 row_newbcast:0 row_mask:0xf bank_mask:0xf
    v_mfma_f32_16x16x32_bf16 v[20:23], v[36:39], v[236:239], v[20:23]
    v_and_b32_dpp v36, v27, v16 row_newbcast:4 row_mask:0xf bank_mask:0xf
    v_and_b32_dpp v37, v27, v17 row_newbcast:4 row_mask:0xf bank_mask:0xf
    v_and_b32_dpp v38, v27, v18 row_newbcast:4 row_mask:0xf bank_mask:0xf
    v_and_b32_dpp v39, v27, v19 row_newbcast:4 row_mask:0xf bank_mask:0xf
    v_mfma_f32_16x16x32_bf16 v[20:23], v[32:35], v[240:243], v[20:23]
    v_and_b32_dpp v32, v27, v16 row_newbcast:8 row_mask:0xf bank_mask:0xf
    v_and_b32_dpp v33, v27, v17 row_newbcast:8 row_mask:0xf bank_mask:0xf
    v_and_b32_dpp v34, v27, v18 row_newbcast:8 row_mask:0xf bank_mask:0xf
    v_and_b32_dpp v35, v27, v19 row_newbcast:8 row_mask:0xf bank_mask:0xf
    v_mfma_f32_16x16x32_bf16 v[20:23], v[36:39], v[244:247], v[20:23]
    v_and_b32_dpp v36, v27, v16 row_newbcast:12 row_mask:0xf bank_mask:0xf
    v_and_b32_dpp v37, v27, v17 row_newbcast:12 row_mask:0xf bank_mask:0xf
    v_and_b32_dpp v38, v27, v18 row_newbcast:12 row_mask:0xf bank_mask:0xf
    v_and_b32_dpp v39, v27, v19 row_newbcast:12 row_mask:0xf bank_mask:0xf
    v_mfma_f32_16x16x32_bf16 v[20:23], v[32:35], v[248:251], v[20:23]
    v_and_b32_dpp v32, v28, v16 row_newbcast:0 row_mask:0xf bank_mask:0xf
    v_and_b32_dpp v33, v28, v17 row_newbcast:0 row_mask:0xf bank_mask:0xf
    v_and_b32_dpp v34, v28, v18 row_newbcast:0 row_mask:0xf bank_mask:0xf
    v_and_b32_dpp v35, v28, v19 row_newbcast:0 row_mask:0xf bank_mask:0xf
    v_mfma_f32_16x16x32_bf16 v[20:23], v[36:39], v[252:255], v[20:23]
    v_and_b32_dpp v36, v28, v16 row_newbcast:4 row_mask:0xf bank_mask:0xf
    v_and_b32_dpp v37, v28, v17 row_newbcast:4 row_mask:0xf bank_mask:0xf
    v_and_b32_dpp v38, v28, v18 row_newbcast:4 row_mask:0xf bank_mask:0xf
    v_and_b32_dpp v39, v28, v19 row_newbcast:4 row_mask:0xf bank_mask:0xf
    v_mfma_f32_16x16x32_bf16 v[20:23], v[32:35], v[64:67], v[20:23]
    v_and_b32_dpp v32, v28, v16 row_newbcast:8 row_mask:0xf bank_mask:0xf
    v_and_b32_dpp v33, v28, v17 row_newbcast:8 row_mask:0xf bank_mask:0xf
    v_and_b32_dpp v34, v28, v18 row_newbcast:8 row_mask:0xf bank_mask:0xf
    v_and_b32_dpp v35, v28, v19 row_newbcast:8 row_mask:0xf bank_mask:0xf
    v_mfma_f32_16x16x32_bf16 v[20:23], v[36:39], v[68:71], v[20:23]
    v_and_b32_dpp v36, v28, v16 row_newbcast:12 row_mask:0xf bank_mask:0xf
    v_and_b32_dpp v37, v28, v17 row_newbcast:12 row_mask:0xf bank_mask:0xf
    v_and_b32_dpp v38, v28, v18 row_newbcast:12 row_mask:0xf bank_mask:0xf
    v_and_b32_dpp v39, v28, v19 row_newbcast:12 row_mask:0xf bank_mask:0xf
    v_mfma_f32_16x16x32_bf16 v[20:23], v[32:35], v[72:75], v[20:23]
    s_waitcnt vmcnt(9)
    s_mul_i32 s86, s13, 27648
    buffer_load_dwordx4 v[108:111], v5, s[48:51], s86 offen nt
    v_and_b32_dpp v32, v29, v16 row_newbcast:0 row_mask:0xf bank_mask:0xf
    v_and_b32_dpp v33, v29, v17 row_newbcast:0 row_mask:0xf bank_mask:0xf
    v_and_b32_dpp v34, v29, v18 row_newbcast:0 row_mask:0xf bank_mask:0xf
    v_and_b32_dpp v35, v29, v19 row_newbcast:0 row_mask:0xf bank_mask:0xf
    v_mfma_f32_16x16x32_bf16 v[20:23], v[36:39], v[76:79], v[20:23]
    s_waitcnt vmcnt(9)
    s_mul_i32 s86, s13, 28672
    buffer_load_dwordx4 v[112:115], v5, s[48:51], s86 offen nt
    v_and_b32_dpp v36, v29, v16 row_newbcast:4 row_mask:0xf bank_mask:0xf
    v_and_b32_dpp v37, v29, v17 row_newbcast:4 row_mask:0xf bank_mask:0xf
    v_and_b32_dpp v38, v29, v18 row_newbcast:4 row_mask:0xf bank_mask:0xf
    v_and_b32_dpp v39, v29, v19 row_newbcast:4 row_mask:0xf bank_mask:0xf
    v_mfma_f32_16x16x32_bf16 v[20:23], v[32:35], v[80:83], v[20:23]
    s_waitcnt vmcnt(7)
    s_mul_i32 s86, s13, 29696
    buffer_load_dwordx4 v[116:119], v5, s[48:51], s86 offen nt
    v_and_b32_dpp v32, v29, v16 row_newbcast:8 row_mask:0xf bank_mask:0xf
    v_and_b32_dpp v33, v29, v17 row_newbcast:8 row_mask:0xf bank_mask:0xf
    v_and_b32_dpp v34, v29, v18 row_newbcast:8 row_mask:0xf bank_mask:0xf
    v_and_b32_dpp v35, v29, v19 row_newbcast:8 row_mask:0xf bank_mask:0xf
    v_mfma_f32_16x16x32_bf16 v[20:23], v[36:39], v[84:87], v[20:23]
    s_waitcnt vmcnt(7)
    s_mul_i32 s86, s13, 30720
    buffer_load_dwordx4 v[120:123], v5, s[48:51], s86 offen nt
    v_and_b32_dpp v36, v29, v16 row_newbcast:12 row_mask:0xf bank_mask:0xf
    v_and_b32_dpp v37, v29, v17 row_newbcast:12 row_mask:0xf bank_mask:0xf
    v_and_b32_dpp v38, v29, v18 row_newbcast:12 row_mask:0xf bank_mask:0xf
    v_and_b32_dpp v39, v29, v19 row_newbcast:12 row_mask:0xf bank_mask:0xf
    v_mfma_f32_16x16x32_bf16 v[20:23], v[32:35], v[88:91], v[20:23]
    s_waitcnt vmcnt(7)
    s_mul_i32 s86, s13, 31744
    buffer_load_dwordx4 v[124:127], v5, s[48:51], s86 offen nt
    v_and_b32_dpp v32, v30, v16 row_newbcast:0 row_mask:0xf bank_mask:0xf
    v_and_b32_dpp v33, v30, v17 row_newbcast:0 row_mask:0xf bank_mask:0xf
    v_and_b32_dpp v34, v30, v18 row_newbcast:0 row_mask:0xf bank_mask:0xf
    v_and_b32_dpp v35, v30, v19 row_newbcast:0 row_mask:0xf bank_mask:0xf
    v_mfma_f32_16x16x32_bf16 v[20:23], v[36:39], v[92:95], v[20:23]
    s_lshl_b32 s8, s3, 9
    v_lshlrev_b32 v40, 5, v3
    v_lshl_add_u32 v40, v2, 4, v40
    v_add_u32 v40, s8, v40
    v_lshlrev_b32 v41, 3, v1
    s_lshl_b32 s88, s87, 8
    s_add_u32 s88, s88, 0x30000
    v_lshlrev_b32 v42, 8, v146
    v_lshl_add_u32 v42, v2, 4, v42
    v_lshrrev_b32 v9, 3, v1
    v_lshlrev_b32 v45, 10, v9
    v_lshl_add_u32 v45, v146, 4, v45
    s_cmp_lt_i32 s98, 0
    s_cbranch_scc1 L_tp_done
    s_lshl_b32 s8, s3, 10
    s_add_u32 s8, s8, 136192
    v_lshrrev_b32 v8, 3, v3
    v_lshlrev_b32 v48, 7, v146
    v_lshl_add_u32 v48, v8, 6, v48
    v_lshl_add_u32 v48, v2, 4, v48
    v_add_u32 v48, s8, v48
    v_add_u32 v49, 136192, v5
    s_lshl_b32 s89, s4, 13
    s_lshr_b32 s8, s3, 1
    s_lshl_b32 s8, s8, 11
    s_add_u32 s89, s89, s8
    s_and_b32 s8, s3, 1
    s_lshl_b32 s8, s8, 7
    s_add_u32 s89, s89, s8
    s_add_u32 s89, s89, 0x30000
    s_lshl_b32 s94, s96, 10
    s_add_u32 s94, s94, 0x60000
    s_lshl_b32 s92, s98, 13
    s_lshl_b32 s8, s3, 7
    s_add_u32 s92, s92, s8
    s_add_u32 s92, s92, 0x60000
    s_lshl_b32 s43, s98, 9
    s_lshl_b32 s9, s3, 6
    s_add_u32 s42, s43, s9
    s_add_u32 s91, s42, s90
    s_add_u32 s42, s42, 20480
    s_lshl_b32 s9, s4, 3
    s_add_u32 s43, s43, s9
    s_add_u32 s99, s43, s90
    s_add_u32 s43, s43, 51200
    s_mul_i32 s9, s3, 1280
    s_lshl_b32 s10, s98, 6
    s_add_u32 s9, s9, s10
    buffer_load_dword v145, v148, s[68:71], s9 offen
    v_lshrrev_b32 v8, 1, v2
    v_lshlrev_b32 v8, 4, v8
    v_sub_u32 v14, 16, v8
    v_lshrrev_b32 v8, 2, v3
    v_lshl_add_u32 v8, v2, 3, v8
    v_lshlrev_b32 v8, 6, v8
    v_lshl_add_u32 v8, v13, 3, v8
    s_lshl_b32 s8, s3, 12
    s_add_u32 s8, s8, 103424
    v_add_u32 v8, s8, v8
    buffer_load_dword v143, v148, s[52:55], s42 offen sc1
    buffer_load_dword v144, v149, s[52:55], s43 offen sc1
    ds_read_b64_tr_b16 v[152:153], v8 offset:0
    ds_read_b64_tr_b16 v[154:155], v8 offset:256
    ds_read_b64_tr_b16 v[156:157], v8 offset:32
    ds_read_b64_tr_b16 v[158:159], v8 offset:288
    ds_read_b64_tr_b16 v[160:161], v8 offset:2048
    ds_read_b64_tr_b16 v[162:163], v8 offset:2304
    ds_read_b64_tr_b16 v[164:165], v8 offset:2080
    ds_read_b64_tr_b16 v[166:167], v8 offset:2336
    s_mov_b32 s14, 400000
    s_branch Lchk_18
Lpoll_17:
    s_lshl_b32 s10, s4, 7
    s_add_u32 s10, s10, 62464
    buffer_load_dword v132, v129, s[52:55], s10 offen sc1
    s_waitcnt vmcnt(0)
Lchk_18:
    v_cmp_eq_u32 vcc, -1, v132
    s_cbranch_vccz Lpd_19
    s_mov_b64 exec, vcc
    s_sleep 1
    s_sub_u32 s14, s14, 1
    s_cbranch_scc0 Lpoll_17
    s_or_b32 s15, s15, 8
Lpd_19:
    s_mov_b64 exec, -1
    s_mov_b32 s14, 400000
Lb_20:
    v_readfirstlane_b32 s8, v128
    s_nop 0
    s_cmp_ge_u32 s8, 8
    s_cbranch_scc1 Lbd_21
    buffer_load_dword v128, off, s[80:83], 0 offset:128 sc1
    s_waitcnt vmcnt(0)
    s_sub_u32 s14, s14, 1
    s_cbranch_scc0 Lb_20
    s_or_b32 s15, s15, 8
Lbd_21:
    buffer_load_dwordx4 v[200:203], v42, s[52:55], s89 offen offset:0 sc1
    buffer_load_dwordx4 v[204:207], v42, s[52:55], s89 offen offset:64 sc1
L_tp_done:
    v_and_b32_dpp v36, v30, v16 row_newbcast:4 row_mask:0xf bank_mask:0xf
    v_and_b32_dpp v37, v30, v17 row_newbcast:4 row_mask:0xf bank_mask:0xf
    v_and_b32_dpp v38, v30, v18 row_newbcast:4 row_mask:0xf bank_mask:0xf
    v_and_b32_dpp v39, v30, v19 row_newbcast:4 row_mask:0xf bank_mask:0xf
    s_waitcnt vmcnt(7)
    v_mfma_f32_16x16x32_bf16 v[20:23], v[32:35], v[96:99], v[20:23]
    v_and_b32_dpp v32, v30, v16 row_newbcast:8 row_mask:0xf bank_mask:0xf
    v_and_b32_dpp v33, v30, v17 row_newbcast:8 row_mask:0xf bank_mask:0xf
    v_and_b32_dpp v34, v30, v18 row_newbcast:8 row_mask:0xf bank_mask:0xf
    v_and_b32_dpp v35, v30, v19 row_newbcast:8 row_mask:0xf bank_mask:0xf
    s_waitcnt vmcnt(6)
    v_mfma_f32_16x16x32_bf16 v[20:23], v[36:39], v[100:103], v[20:23]
    v_and_b32_dpp v36, v30, v16 row_newbcast:12 row_mask:0xf bank_mask:0xf
    v_and_b32_dpp v37, v30, v17 row_newbcast:12 row_mask:0xf bank_mask:0xf
    v_and_b32_dpp v38, v30, v18 row_newbcast:12 row_mask:0xf bank_mask:0xf
    v_and_b32_dpp v39, v30, v19 row_newbcast:12 row_mask:0xf bank_mask:0xf
    s_waitcnt vmcnt(5)
    v_mfma_f32_16x16x32_bf16 v[20:23], v[32:35], v[104:107], v[20:23]
    v_and_b32_dpp v32, v31, v16 row_newbcast:0 row_mask:0xf bank_mask:0xf
    v_and_b32_dpp v33, v31, v17 row_newbcast:0 row_mask:0xf bank_mask:0xf
    v_and_b32_dpp v34, v31, v18 row_newbcast:0 row_mask:0xf bank_mask:0xf
    v_and_b32_dpp v35, v31, v19 row_newbcast:0 row_mask:0xf bank_mask:0xf
    s_waitcnt vmcnt(4)
    v_mfma_f32_16x16x32_bf16 v[20:23], v[36:39], v[108:111], v[20:23]
    v_and_b32_dpp v36, v31, v16 row_newbcast:4 row_mask:0xf bank_mask:0xf
    v_and_b32_dpp v37, v31, v17 row_newbcast:4 row_mask:0xf bank_mask:0xf
    v_and_b32_dpp v38, v31, v18 row_newbcast:4 row_mask:0xf bank_mask:0xf
    v_and_b32_dpp v39, v31, v19 row_newbcast:4 row_mask:0xf bank_mask:0xf
    s_waitcnt vmcnt(3)
    v_mfma_f32_16x16x32_bf16 v[20:23], v[32:35], v[112:115], v[20:23]
    v_and_b32_dpp v32, v31, v16 row_newbcast:8 row_mask:0xf bank_mask:0xf
    v_and_b32_dpp v33, v31, v17 row_newbcast:8 row_mask:0xf bank_mask:0xf
    v_and_b32_dpp v34, v31, v18 row_newbcast:8 row_mask:0xf bank_mask:0xf
    v_and_b32_dpp v35, v31, v19 row_newbcast:8 row_mask:0xf bank_mask:0xf
    s_waitcnt vmcnt(2)
    v_mfma_f32_16x16x32_bf16 v[20:23], v[36:39], v[116:119], v[20:23]
    v_and_b32_dpp v36, v31, v16 row_newbcast:12 row_mask:0xf bank_mask:0xf
    v_and_b32_dpp v37, v31, v17 row_newbcast:12 row_mask:0xf bank_mask:0xf
    v_and_b32_dpp v38, v31, v18 row_newbcast:12 row_mask:0xf bank_mask:0xf
    v_and_b32_dpp v39, v31, v19 row_newbcast:12 row_mask:0xf bank_mask:0xf
    s_waitcnt vmcnt(1)
    v_mfma_f32_16x16x32_bf16 v[20:23], v[32:35], v[120:123], v[20:23]
    s_nop 1
    s_waitcnt vmcnt(0)
    v_mfma_f32_16x16x32_bf16 v[20:23], v[36:39], v[124:127], v[20:23]
L_tail:
    s_mov_b32 exec_hi, 0
    s_nop 6
    ds_write_b128 v40, v[20:23] offset:11264
    s_mov_b64 exec, -1
    v_cmp_ne_u32 vcc, s97, v132
    s_cmp_eq_u64 vcc, 0
    s_cselect_b32 s95, 1, 0
    s_waitcnt lgkmcnt(0)
    s_barrier
    s_cmp_eq_u32 s3, 0
    s_cbranch_scc0 L_opub
    s_mov_b32 exec_hi, 0
    ds_read_b128 v[64:67], v5 offset:11264
    ds_read_b128 v[68:71], v5 offset:11776
    ds_read_b128 v[72:75], v5 offset:12288
    ds_read_b128 v[76:79], v5 offset:12800
    ds_read_b128 v[80:83], v5 offset:13312
    ds_read_b128 v[84:87], v5 offset:13824
    ds_read_b128 v[88:91], v5 offset:14336
    ds_read_b128 v[92:95], v5 offset:14848
    s_waitcnt lgkmcnt(6)
    v_pk_add_f32 v[64:65], v[64:65], v[68:69]
    v_pk_add_f32 v[66:67], v[66:67], v[70:71]
    s_waitcnt lgkmcnt(4)
    v_pk_add_f32 v[72:73], v[72:73], v[76:77]
    v_pk_add_f32 v[74:75], v[74:75], v[78:79]
    v_pk_add_f32 v[64:65], v[64:65], v[72:73]
    v_pk_add_f32 v[66:67], v[66:67], v[74:75]
    s_waitcnt lgkmcnt(2)
    v_pk_add_f32 v[80:81], v[80:81], v[84:85]
    v_pk_add_f32 v[82:83], v[82:83], v[86:87]
    s_waitcnt lgkmcnt(0)
    v_pk_add_f32 v[88:89], v[88:89], v[92:93]
    v_pk_add_f32 v[90:91], v[90:91], v[94:95]
    v_pk_add_f32 v[80:81], v[80:81], v[88:89]
    v_pk_add_f32 v[82:83], v[82:83], v[90:91]
    v_pk_add_f32 v[64:65], v[64:65], v[80:81]
    v_pk_add_f32 v[66:67], v[66:67], v[82:83]
    v_cvt_pk_bf16_f32 v46, v64, v65
    v_cvt_pk_bf16_f32 v47, v66, v67
    v_min_u32 v46, -2, v46
    v_min_u32 v47, -2, v47
    s_cmp_eq_u32 s95, 1
    s_cbranch_scc0 Lwt_22
    buffer_store_dwordx2 v[46:47], v41, s[52:55], s88 offen
    s_branch Lsd_23
Lwt_22:
    buffer_store_dwordx2 v[46:47], v41, s[52:55], s88 offen sc1
Lsd_23:
    s_mov_b64 exec, -1
L_opub:
    s_cmp_eq_u32 s100, 1
    s_cbranch_scc1 L_mlp
    s_cmp_eq_u32 s100, 2
    s_cbranch_scc0 L_fin
    s_mov_b32 s14, 400000
    s_branch Lchk_25
Lpoll_24:
    buffer_load_dword v143, v148, s[52:55], s42 offen sc1
    buffer_load_dword v144, v149, s[52:55], s43 offen sc1
    s_waitcnt vmcnt(0)
Lchk_25:
    v_max_u32 v8, v143, v144
    v_cmp_eq_u32 vcc, -1, v8
    s_cbranch_vccz Lpd_26
    s_mov_b64 exec, vcc
    s_sleep 1
    s_sub_u32 s14, s14, 1
    s_cbranch_scc0 Lpoll_24
    s_or_b32 s15, s15, 8
Lpd_26:
    s_mov_b64 exec, -1
    v_lshlrev_b32 v208, v14, v143
    v_and_b32 v208, 0xffff0000, v208
    v_lshlrev_b32 v209, v14, v145
    v_and_b32 v209, 0xffff0000, v209
    s_mov_b32 s14, 400000
    s_branch Lchk_28
Lpoll_27:
    buffer_load_dwordx4 v[200:203], v42, s[52:55], s89 offen offset:0 sc1
    buffer_load_dwordx4 v[204:207], v42, s[52:55], s89 offen offset:64 sc1
    s_waitcnt vmcnt(0)
Lchk_28:
    v_max3_u32 v8, v200, v201, v202
    v_max3_u32 v8, v8, v203, v204
    v_max3_u32 v8, v8, v205, v206
    v_max_u32 v8, v8, v207
    v_cmp_eq_u32 vcc, -1, v8
    s_cbranch_vccz Lpd_29
    s_mov_b64 exec, vcc
    s_sub_u32 s14, s14, 1
    s_cbranch_scc0 Lpoll_27
    s_or_b32 s15, s15, 512
Lpd_29:
    s_mov_b64 exec, -1
    v_mfma_f32_16x16x32_bf16 v[96:99], v[152:155], v[200:203], 0
    v_mfma_f32_16x16x32_bf16 v[100:103], v[156:159], v[200:203], 0
    v_mfma_f32_16x16x32_bf16 v[96:99], v[160:163], v[204:207], v[96:99]
    v_mfma_f32_16x16x32_bf16 v[100:103], v[164:167], v[204:207], v[100:103]
    v_cmp_lt_u32 vcc, 7, v3
    s_nop 6
    v_cndmask_b32 v96, v96, v100, vcc
    v_cndmask_b32 v97, v97, v101, vcc
    v_cndmask_b32 v98, v98, v102, vcc
    v_cndmask_b32 v99, v99, v103, vcc
    ds_write_b128 v48, v[96:99]
    s_waitcnt lgkmcnt(0)
    s_barrier
    s_cmp_eq_u32 s3, 0
    s_cbranch_scc0 L_apdone
    ds_read_b128 v[64:67], v49 offset:0
    ds_read_b128 v[68:71], v49 offset:1024
    ds_read_b128 v[72:75], v49 offset:2048
    ds_read_b128 v[76:79], v49 offset:3072
    ds_read_b128 v[80:83], v49 offset:4096
    ds_read_b128 v[84:87], v49 offset:5120
    ds_read_b128 v[88:91], v49 offset:6144
    ds_read_b128 v[92:95], v49 offset:7168
    s_waitcnt lgkmcnt(6)
    v_pk_add_f32 v[64:65], v[64:65], v[68:69]
    v_pk_add_f32 v[66:67], v[66:67], v[70:71]
    s_waitcnt lgkmcnt(4)
    v_pk_add_f32 v[72:73], v[72:73], v[76:77]
    v_pk_add_f32 v[74:75], v[74:75], v[78:79]
    v_pk_add_f32 v[64:65], v[64:65], v[72:73]
    v_pk_add_f32 v[66:67], v[66:67], v[74:75]
    s_waitcnt lgkmcnt(2)
    v_pk_add_f32 v[80:81], v[80:81], v[84:85]
    v_pk_add_f32 v[82:83], v[82:83], v[86:87]
    s_waitcnt lgkmcnt(0)
    v_pk_add_f32 v[88:89], v[88:89], v[92:93]
    v_pk_add_f32 v[90:91], v[90:91], v[94:95]
    v_pk_add_f32 v[80:81], v[80:81], v[88:89]
    v_pk_add_f32 v[82:83], v[82:83], v[90:91]
    v_pk_add_f32 v[64:65], v[64:65], v[80:81]
    v_pk_add_f32 v[66:67], v[66:67], v[82:83]
    v_min_u32 v96, -2, v64
    v_min_u32 v97, -2, v65
    v_min_u32 v98, -2, v66
    v_min_u32 v99, -2, v67
    buffer_store_dwordx4 v[96:99], v5, s[52:55], s94 offen sc1
L_apdone:
    s_sleep 16
    s_mov_b32 s14, 400000
Lpoll_30:
    buffer_load_dwordx4 v[64:67], v45, s[52:55], s92 offen sc1
    s_waitcnt vmcnt(0)
Lchk_31:
    v_max3_u32 v8, v64, v65, v66
    v_max_u32 v8, v8, v67
    v_cmp_eq_u32 vcc, -1, v8
    s_cbranch_vccz Lpd_32
    s_mov_b64 exec, vcc
    s_sub_u32 s14, s14, 1
    s_cbranch_scc0 Lpoll_30
    s_or_b32 s15, s15, 16
Lpd_32:
    s_mov_b64 exec, -1
    v_permlane32_swap_b32 v64, v65
    v_permlane32_swap_b32 v66, v67
    v_add_f32 v64, v64, v65
    v_add_f32 v66, v66, v67
    s_nop 1
    v_permlane16_swap_b32 v64, v66
    v_add_f32 v64, v64, v66
    s_nop 1
    v_add_f32_dpp v64, v64, v64 row_ror:8 row_mask:0xf bank_mask:0xf
    v_cvt_pk_bf16_f32 v64, 0, v64
    v_mul_f32 v64, v64, v208
    v_cvt_pk_bf16_f32 v64, 0, v64
    v_add_f32 v64, v64, v209
    v_mov_b32 v65, v64
    s_nop 1
    v_permlane32_swap_b32 v64, v65
    v_cvt_pk_bf16_f32 v68, v64, v65
    v_cvt_pk_bf16_f32 v69, v64, v65
    s_nop 1
    v_permlane16_swap_b32 v68, v69
    v_min_u32 v68, -2, v68
    v_min_u32 v69, -2, v69
    s_mov_b64 exec, 0xff
    s_cmp_eq_u32 s95, 1
    s_cbranch_scc0 Lwt_33
    buffer_store_dwordx2 v[68:69], v41, s[52:55], s91 offen
    s_branch Lsd_34
Lwt_33:
    buffer_store_dwordx2 v[68:69], v41, s[52:55], s91 offen sc1
Lsd_34:
    s_mov_b64 exec, -1
    s_cmp_eq_u32 s3, 7
    s_cbranch_scc0 L_fin
    v_lshlrev_b32 v208, v14, v144
    v_and_b32 v208, 0xffff0000, v208
    v_mul_u32_u24 v10, 20480, v9
    v_lshl_add_u32 v10, v146, 4, v10
    v_mul_u32_u24 v12, 1280, v1
    s_lshl_b32 s8, s96, 7
    s_add_u32 s8, s8, 0x180000
    s_add_u32 s9, s8, 163840
    s_add_u32 s10, s8, 327680
    s_add_u32 s11, s8, 491520
    s_lshl_b32 s88, s96, 3
    s_mov_b32 s14, 400000
Lpoll_35:
    buffer_load_dword v145, v149, s[52:55], s99 offen sc1
    s_waitcnt vmcnt(0)
Lchk_36:
    v_cmp_eq_u32 vcc, -1, v145
    s_cbranch_vccz Lpd_37
    s_mov_b64 exec, vcc
    s_sleep 2
    s_sub_u32 s14, s14, 1
    s_cbranch_scc0 Lpoll_35
    s_or_b32 s15, s15, 32
Lpd_37:
    s_mov_b64 exec, -1
    v_lshlrev_b32 v209, v14, v145
    v_and_b32 v209, 0xffff0000, v209
    s_mov_b32 s14, 400000
Lpoll_38:
    buffer_load_dwordx4 v[64:67], v10, s[52:55], s8 offen sc1
    buffer_load_dwordx4 v[68:71], v10, s[52:55], s9 offen sc1
    buffer_load_dwordx4 v[72:75], v10, s[52:55], s10 offen sc1
    buffer_load_dwordx4 v[76:79], v10, s[52:55], s11 offen sc1
    s_waitcnt vmcnt(0)
Lchk_39:
    v_max3_u32 v13, v64, v65, v66
    v_max3_u32 v13, v13, v67, v68
    v_max3_u32 v13, v13, v69, v70
    v_max3_u32 v13, v13, v71, v72
    v_max3_u32 v13, v13, v73, v74
    v_max3_u32 v13, v13, v75, v76
    v_max3_u32 v13, v13, v77, v78
    v_max_u32 v13, v13, v79
    v_cmp_eq_u32 vcc, -1, v13
    s_cbranch_vccz Lpd_40
    s_mov_b64 exec, vcc
    s_sub_u32 s14, s14, 1
    s_cbranch_scc0 Lpoll_38
    s_or_b32 s15, s15, 16
Lpd_40:
    s_mov_b64 exec, -1
    v_pk_add_f32 v[64:65], v[64:65], v[68:69]
    v_pk_add_f32 v[66:67], v[66:67], v[70:71]
    v_pk_add_f32 v[72:73], v[72:73], v[76:77]
    v_pk_add_f32 v[74:75], v[74:75], v[78:79]
    v_pk_add_f32 v[64:65], v[64:65], v[72:73]
    v_pk_add_f32 v[66:67], v[66:67], v[74:75]
    s_nop 0
    v_permlane32_swap_b32 v64, v65
    v_permlane32_swap_b32 v66, v67
    v_add_f32 v64, v64, v65
    v_add_f32 v66, v66, v67
    s_nop 1
    v_permlane16_swap_b32 v64, v66
    v_add_f32 v64, v64, v66
    s_nop 1
    v_add_f32_dpp v64, v64, v64 row_ror:8 row_mask:0xf bank_mask:0xf
    v_cvt_pk_bf16_f32 v64, 0, v64
    v_mul_f32 v64, v64, v208
    v_cvt_pk_bf16_f32 v64, 0, v64
    v_add_f32 v64, v64, v209
    v_mov_b32 v65, v64
    s_nop 1
    v_permlane32_swap_b32 v64, v65
    v_cvt_pk_bf16_f32 v68, v64, v65
    v_cvt_pk_bf16_f32 v69, v64, v65
    s_nop 1
    v_permlane16_swap_b32 v68, v69
    s_mov_b64 exec, 0xff
    buffer_store_dwordx2 v[68:69], v12, s[76:79], s88 offen
    s_mov_b64 exec, -1
    s_branch L_fin
L_mlp:
    v_lshrrev_b32 v14, 3, v1
    v_mul_u32_u24 v14, 3456, v14
    v_and_b32 v12, 1, v2
    v_lshlrev_b32 v12, 1, v12
    v_and_b32 v15, 7, v1
    v_xor_b32 v15, v15, v12
    v_xor_b32 v12, 4, v15
    v_lshl_add_u32 v15, v15, 4, v14
    v_lshl_add_u32 v14, v12, 4, v14
    v_add_u32 v14, 26624, v14
    s_mul_i32 s86, s3, 276480
    s_add_u32 s86, s86, 0
    s_mul_i32 s87, s3, 10240
    s_add_u32 m0, s87, 21504
    s_add_u32 s87, s87, 31744
    s_barrier
L_t1:
    buffer_load_dwordx4 v15, s[60:63], s86 offen  lds
    buffer_load_dwordx4 v14, s[60:63], s86 offen offset:1024  lds
    s_add_u32 m0, m0, 2048
    s_add_u32 s86, s86, 55296
    s_cmp_lt_u32 m0, s87
    s_cbranch_scc1 L_t1
    v_lshlrev_b32 v12, 1, v2
    v_xor_b32 v12, v12, v3
    v_mul_u32_u24 v14, 1280, v2
    v_lshl_add_u32 v15, v12, 4, v14
    v_xor_b32 v12, 8, v12
    v_lshl_add_u32 v14, v12, 4, v14
    v_add_u32 v14, 4096, v14
    s_lshl_b32 s87, s3, 11
    s_add_u32 m0, s87, 103424
    s_mul_i32 s86, s3, 10240
    buffer_load_dwordx4 v15, s[64:67], s86 offen nt lds
    buffer_load_dwordx4 v14, s[64:67], s86 offen offset:1024 nt lds
    s_cmp_eq_u32 s93, 2
    s_cbranch_scc1 L_mlp_nt
    s_add_u32 m0, m0, 16384
    s_add_u32 s86, s86, 256
    buffer_load_dwordx4 v15, s[64:67], s86 offen nt lds
    buffer_load_dwordx4 v14, s[64:67], s86 offen offset:1024 nt lds
L_mlp_nt:
    v_add_u32 v8, 136192, v7
    ds_read_b32 v133, v8 offset:10240
    ds_read_b32 v134, v8 offset:12288
    ds_read_b32 v135, v8 offset:14336
    ds_read_b32 v136, v8 offset:16384
    ds_read_b32 v137, v8 offset:18432
    ds_read_b32 v138, v8 offset:0
    ds_read_b32 v139, v8 offset:2048
    ds_read_b32 v140, v8 offset:4096
    ds_read_b32 v141, v8 offset:6144
    ds_read_b32 v142, v8 offset:8192
    s_waitcnt lgkmcnt(0)
    s_mov_b32 s14, 400000
    s_branch Lchk_42
Lpoll_41:
    s_lshl_b32 s10, s4, 7
    s_add_u32 s10, s10, 62464
    buffer_load_dword v132, v129, s[52:55], s10 offen sc1
    s_mov_b32 s9, 40960
    buffer_load_dword v133, v7, s[52:55], s9 offen sc1
    s_mov_b32 s9, 43008
    buffer_load_dword v134, v7, s[52:55], s9 offen sc1
    s_mov_b32 s9, 45056
    buffer_load_dword v135, v7, s[52:55], s9 offen sc1
    s_mov_b32 s9, 47104
    buffer_load_dword v136, v7, s[52:55], s9 offen sc1
    s_mov_b32 s9, 49152
    buffer_load_dword v137, v7, s[52:55], s9 offen sc1
    s_mov_b32 s9, 30720
    buffer_load_dword v138, v7, s[52:55], s9 offen sc1
    s_mov_b32 s9, 32768
    buffer_load_dword v139, v7, s[52:55], s9 offen sc1
    s_mov_b32 s9, 34816
    buffer_load_dword v140, v7, s[52:55], s9 offen sc1
    s_mov_b32 s9, 36864
    buffer_load_dword v141, v7, s[52:55], s9 offen sc1
    s_mov_b32 s9, 38912
    buffer_load_dword v142, v7, s[52:55], s9 offen sc1
    s_waitcnt vmcnt(0)
Lchk_42:
    v_max3_u32 v8, v132, v133, v134
    v_max3_u32 v8, v8, v135, v136
    v_max3_u32 v8, v8, v137, v138
    v_max3_u32 v8, v8, v139, v140
    v_max3_u32 v8, v8, v141, v142
    v_cmp_eq_u32 vcc, -1, v8
    s_cbranch_vccz Lpd_43
    s_mov_b64 exec, vcc
    s_sleep 1
    s_sub_u32 s14, s14, 1
    s_cbranch_scc0 Lpoll_41
    s_or_b32 s15, s15, 64
Lpd_43:
    s_mov_b64 exec, -1
    v_lshlrev_b32 v208, 16, v133
    v_and_b32 v209, 0xffff0000, v133
    v_add_f32 v208, 1.0, v208
    v_add_f32 v209, 1.0, v209
    v_cvt_pk_bf16_f32 v8, v208, v209
    v_lshlrev_b32 v208, 16, v8
    v_and_b32 v209, 0xffff0000, v8
    v_lshlrev_b32 v218, 16, v138
    v_and_b32 v219, 0xffff0000, v138
    v_lshlrev_b32 v210, 16, v134
    v_and_b32 v211, 0xffff0000, v134
    v_add_f32 v210, 1.0, v210
    v_add_f32 v211, 1.0, v211
    v_cvt_pk_bf16_f32 v8, v210, v211
    v_lshlrev_b32 v210, 16, v8
    v_and_b32 v211, 0xffff0000, v8
    v_lshlrev_b32 v220, 16, v139
    v_and_b32 v221, 0xffff0000, v139
    v_lshlrev_b32 v212, 16, v135
    v_and_b32 v213, 0xffff0000, v135
    v_add_f32 v212, 1.0, v212
    v_add_f32 v213, 1.0, v213
    v_cvt_pk_bf16_f32 v8, v212, v213
    v_lshlrev_b32 v212, 16, v8
    v_and_b32 v213, 0xffff0000, v8
    v_lshlrev_b32 v222, 16, v140
    v_and_b32 v223, 0xffff0000, v140
    v_lshlrev_b32 v214, 16, v136
    v_and_b32 v215, 0xffff0000, v136
    v_add_f32 v214, 1.0, v214
    v_add_f32 v215, 1.0, v215
    v_cvt_pk_bf16_f32 v8, v214, v215
    v_lshlrev_b32 v214, 16, v8
    v_and_b32 v215, 0xffff0000, v8
    v_lshlrev_b32 v224, 16, v141
    v_and_b32 v225, 0xffff0000, v141
    v_lshlrev_b32 v216, 16, v137
    v_and_b32 v217, 0xffff0000, v137
    v_add_f32 v216, 1.0, v216
    v_add_f32 v217, 1.0, v217
    v_cvt_pk_bf16_f32 v8, v216, v217
    v_lshlrev_b32 v216, 16, v8
    v_and_b32 v217, 0xffff0000, v8
    v_lshlrev_b32 v226, 16, v142
    v_and_b32 v227, 0xffff0000, v142
    v_lshrrev_b32 v8, 2, v3
    v_lshlrev_b32 v10, 10, v2
    v_lshl_add_u32 v10, v8, 7, v10
    v_lshl_add_u32 v10, v13, 3, v10
    s_lshr_b32 s8, s3, 1
    s_mul_i32 s9, s8, 20480
    s_add_u32 s9, s9, 21504
    v_add_u32 v10, s9, v10
    v_and_b32 v9, 1, v2
    v_lshrrev_b32 v12, 3, v3
    v_lshl_add_u32 v12, v9, 1, v12
    s_and_b32 s10, s3, 1
    s_lshl_b32 s10, s10, 1
    v_xor_b32 v12, s10, v12
    v_xor_b32 v184, 1, v12
    v_lshl_add_u32 v184, v184, 5, v10
    v_lshl_add_u32 v10, v12, 5, v10
    v_lshl_add_u32 v11, v2, 2, v8
    v_lshlrev_b32 v11, 8, v11
    v_lshl_add_u32 v11, v13, 3, v11
    v_add_u32 v11, 103424, v11
    v_lshl_add_u32 v12, v9, 2, v8
    s_and_b32 s9, s3, 3
    s_lshl_b32 s9, s9, 1
    v_xor_b32 v12, s9, v12
    v_xor_b32 v185, 1, v12
    v_lshl_add_u32 v185, v185, 5, v11
    v_lshl_add_u32 v11, v12, 5, v11
    v_lshlrev_b32 v186, 6, v146
    v_lshl_add_u32 v186, v2, 4, v186
    s_mul_i32 s9, s8, 2560
    v_add_u32 v186, s9, v186
    s_lshl_b32 s9, s3, 11
    s_add_u32 s9, s9, 136192
    v_add_u32 v187, s9, v5
    v_lshrrev_b32 v9, 3, v3
    v_lshlrev_b32 v188, 10, v9
    v_lshl_add_u32 v188, v2, 8, v188
    v_lshl_add_u32 v188, v146, 4, v188
    v_add_u32 v188, 136192, v188
    v_lshlrev_b32 v190, 4, v146
    v_lshl_add_u32 v190, v2, 7, v190
    s_add_u32 s43, s90, 4096
    s_add_u32 s89, s90, 8192
    s_lshl_b32 s9, s3, 10
    s_add_u32 s42, s101, s9
    s_mov_b32 s86, 0x00ff00ff
    s_mov_b32 s87, 0x00ff00ff
    s_add_u32 s88, s42, 4096
    s_waitcnt vmcnt(0)
    s_barrier
    buffer_load_dword v24, v7, s[52:55], s90 offen offset:0 sc1
    buffer_load_dword v25, v7, s[52:55], s90 offen offset:2048 sc1
    buffer_load_dword v26, v7, s[52:55], s43 offen offset:0 sc1
    buffer_load_dword v27, v7, s[52:55], s43 offen offset:2048 sc1
    buffer_load_dword v28, v7, s[52:55], s89 offen offset:0 sc1
    ds_read_b64_tr_b16 v[64:65], v10 offset:0
    ds_read_b64_tr_b16 v[66:67], v10 offset:512
    ds_read_b64_tr_b16 v[68:69], v184 offset:0
    ds_read_b64_tr_b16 v[70:71], v184 offset:512
    ds_read_b64_tr_b16 v[72:73], v10 offset:4096
    ds_read_b64_tr_b16 v[74:75], v10 offset:4608
    ds_read_b64_tr_b16 v[76:77], v184 offset:4096
    ds_read_b64_tr_b16 v[78:79], v184 offset:4608
    ds_read_b64_tr_b16 v[80:81], v10 offset:8192
    ds_read_b64_tr_b16 v[82:83], v10 offset:8704
    ds_read_b64_tr_b16 v[84:85], v184 offset:8192
    ds_read_b64_tr_b16 v[86:87], v184 offset:8704
    ds_read_b64_tr_b16 v[88:89], v10 offset:12288
    ds_read_b64_tr_b16 v[90:91], v10 offset:12800
    ds_read_b64_tr_b16 v[92:93], v184 offset:12288
    ds_read_b64_tr_b16 v[94:95], v184 offset:12800
    ds_read_b64_tr_b16 v[96:97], v10 offset:16384
    ds_read_b64_tr_b16 v[98:99], v10 offset:16896
    ds_read_b64_tr_b16 v[100:101], v184 offset:16384
    ds_read_b64_tr_b16 v[102:103], v184 offset:16896
    s_cmp_ge_u32 s3, 4
    s_cbranch_scc1 L_now2
    ds_read_b64_tr_b16 v[104:105], v11 offset:0
    ds_read_b64_tr_b16 v[106:107], v11 offset:4096
    ds_read_b64_tr_b16 v[108:109], v11 offset:8192
    ds_read_b64_tr_b16 v[110:111], v11 offset:12288
    ds_read_b64_tr_b16 v[112:113], v185 offset:0
    ds_read_b64_tr_b16 v[114:115], v185 offset:4096
    ds_read_b64_tr_b16 v[116:117], v185 offset:8192
    ds_read_b64_tr_b16 v[118:119], v185 offset:12288
    ds_read_b64_tr_b16 v[120:121], v11 offset:16384
    ds_read_b64_tr_b16 v[122:123], v11 offset:20480
    ds_read_b64_tr_b16 v[124:125], v11 offset:24576
    ds_read_b64_tr_b16 v[126:127], v11 offset:28672
    ds_read_b64_tr_b16 v[128:129], v185 offset:16384
    ds_read_b64_tr_b16 v[130:131], v185 offset:20480
    ds_read_b64_tr_b16 v[132:133], v185 offset:24576
    ds_read_b64_tr_b16 v[134:135], v185 offset:28672
L_now2:
    s_waitcnt vmcnt(0)
    s_mov_b32 s14, 400000
    s_branch Lchk_45
Lpoll_44:
    buffer_load_dword v24, v7, s[52:55], s90 offen offset:0 sc1
    buffer_load_dword v25, v7, s[52:55], s90 offen offset:2048 sc1
    buffer_load_dword v26, v7, s[52:55], s43 offen offset:0 sc1
    buffer_load_dword v27, v7, s[52:55], s43 offen offset:2048 sc1
    buffer_load_dword v28, v7, s[52:55], s89 offen offset:0 sc1
    s_waitcnt vmcnt(0)
Lchk_45:
    v_max3_u32 v8, v24, v25, v26
    v_max3_u32 v8, v8, v27, v28
    v_cmp_eq_u32 vcc, -1, v8
    s_cbranch_vccz Lpd_46
    s_mov_b64 exec, vcc
    s_sub_u32 s14, s14, 1
    s_cbranch_scc0 Lpoll_44
    s_or_b32 s15, s15, 128
Lpd_46:
    s_mov_b64 exec, -1
L_mc:
    v_lshlrev_b32 v32, 16, v24
    v_and_b32 v33, 0xffff0000, v24
    v_readfirstlane_b32 s8, v32
    v_lshlrev_b32 v34, 16, v25
    v_and_b32 v35, 0xffff0000, v25
    v_lshlrev_b32 v36, 16, v26
    v_and_b32 v37, 0xffff0000, v26
    v_lshlrev_b32 v38, 16, v27
    v_and_b32 v39, 0xffff0000, v27
    v_lshlrev_b32 v40, 16, v28
    v_and_b32 v41, 0xffff0000, v28
    v_pk_add_f32 v[42:43], v[32:33], s[8:9] op_sel_hi:[1,0] neg_lo:[0,1] neg_hi:[0,1]
    v_pk_add_f32 v[44:45], v[34:35], s[8:9] op_sel_hi:[1,0] neg_lo:[0,1] neg_hi:[0,1]
    v_pk_add_f32 v[46:47], v[36:37], s[8:9] op_sel_hi:[1,0] neg_lo:[0,1] neg_hi:[0,1]
    v_pk_add_f32 v[48:49], v[38:39], s[8:9] op_sel_hi:[1,0] neg_lo:[0,1] neg_hi:[0,1]
    v_pk_add_f32 v[50:51], v[40:41], s[8:9] op_sel_hi:[1,0] neg_lo:[0,1] neg_hi:[0,1]
    v_pk_add_f32 v[52:53], v[42:43], v[44:45]
    v_pk_mul_f32 v[54:55], v[42:43], v[42:43]
    v_pk_fma_f32 v[54:55], v[44:45], v[44:45], v[54:55]
    v_pk_add_f32 v[52:53], v[52:53], v[46:47]
    v_pk_fma_f32 v[54:55], v[46:47], v[46:47], v[54:55]
    v_pk_add_f32 v[52:53], v[52:53], v[48:49]
    v_pk_fma_f32 v[54:55], v[48:49], v[48:49], v[54:55]
    v_pk_add_f32 v[52:53], v[52:53], v[50:51]
    v_pk_fma_f32 v[54:55], v[50:51], v[50:51], v[54:55]
    v_add_f32 v52, v52, v53
    v_add_f32 v53, v54, v55
    s_nop 0
    v_add_f32_dpp v52, v52, v52 row_ror:1 row_mask:0xf bank_mask:0xf
    v_add_f32_dpp v53, v53, v53 row_ror:1 row_mask:0xf bank_mask:0xf
    s_nop 0
    v_add_f32_dpp v52, v52, v52 row_ror:2 row_mask:0xf bank_mask:0xf
    v_add_f32_dpp v53, v53, v53 row_ror:2 row_mask:0xf bank_mask:0xf
    s_nop 0
    v_add_f32_dpp v52, v52, v52 row_ror:4 row_mask:0xf bank_mask:0xf
    v_add_f32_dpp v53, v53, v53 row_ror:4 row_mask:0xf bank_mask:0xf
    s_nop 0
    v_add_f32_dpp v52, v52, v52 row_ror:8 row_mask:0xf bank_mask:0xf
    v_add_f32_dpp v53, v53, v53 row_ror:8 row_mask:0xf bank_mask:0xf
    s_nop 0
    v_add_f32_dpp v52, v52, v52 row_bcast:15 row_mask:0xa bank_mask:0xf
    v_add_f32_dpp v53, v53, v53 row_bcast:15 row_mask:0xa bank_mask:0xf
    s_nop 0
    v_add_f32_dpp v52, v52, v52 row_bcast:31 row_mask:0xc bank_mask:0xf
    v_add_f32_dpp v53, v53, v53 row_bcast:31 row_mask:0xc bank_mask:0xf
    s_nop 0
    v_readlane_b32 s9, v52, 63
    v_readlane_b32 s10, v53, 63
    v_mov_b32 v54, 0x3acccccd
    s_nop 0
    v_mul_f32 v52, s9, v54
    v_mul_f32 v53, s10, v54
    v_fma_f32 v53, -v52, v52, v53
    v_add_f32 v52, s8, v52
    v_max_f32 v53, 0, v53
    v_cvt_pk_bf16_f32 v52, 0, v52
    v_cvt_pk_bf16_f32 v54, 0, v53
    v_add_f32 v54, 0x3727c5ac, v54
    v_cvt_pk_bf16_f32 v54, 0, v54
    v_sqrt_f32 v54, v54
    v_pk_add_f32 v[32:33], v[32:33], v[52:53] op_sel_hi:[1,0] neg_lo:[0,1] neg_hi:[0,1]
    v_pk_add_f32 v[34:35], v[34:35], v[52:53] op_sel_hi:[1,0] neg_lo:[0,1] neg_hi:[0,1]
    v_pk_add_f32 v[36:37], v[36:37], v[52:53] op_sel_hi:[1,0] neg_lo:[0,1] neg_hi:[0,1]
    v_pk_add_f32 v[38:39], v[38:39], v[52:53] op_sel_hi:[1,0] neg_lo:[0,1] neg_hi:[0,1]
    v_pk_add_f32 v[40:41], v[40:41], v[52:53] op_sel_hi:[1,0] neg_lo:[0,1] neg_hi:[0,1]
    v_cvt_pk_bf16_f32 v54, 0, v54
    v_rcp_f32 v54, v54
    v_cvt_pk_bf16_f32 v32, 0, v32
    v_cvt_pk_bf16_f32 v33, 0, v33
    v_cvt_pk_bf16_f32 v34, 0, v34
    v_cvt_pk_bf16_f32 v35, 0, v35
    v_cvt_pk_bf16_f32 v36, 0, v36
    v_cvt_pk_bf16_f32 v37, 0, v37
    v_cvt_pk_bf16_f32 v38, 0, v38
    v_cvt_pk_bf16_f32 v39, 0, v39
    v_cvt_pk_bf16_f32 v40, 0, v40
    v_cvt_pk_bf16_f32 v41, 0, v41
    v_pk_mul_f32 v[32:33], v[32:33], v[54:55] op_sel_hi:[1,0]
    v_pk_mul_f32 v[34:35], v[34:35], v[54:55] op_sel_hi:[1,0]
    v_pk_mul_f32 v[36:37], v[36:37], v[54:55] op_sel_hi:[1,0]
    v_pk_mul_f32 v[38:39], v[38:39], v[54:55] op_sel_hi:[1,0]
    v_pk_mul_f32 v[40:41], v[40:41], v[54:55] op_sel_hi:[1,0]
    v_cvt_pk_bf16_f32 v32, 0, v32
    v_cvt_pk_bf16_f32 v33, 0, v33
    v_cvt_pk_bf16_f32 v34, 0, v34
    v_cvt_pk_bf16_f32 v35, 0, v35
    v_cvt_pk_bf16_f32 v36, 0, v36
    v_cvt_pk_bf16_f32 v37, 0, v37
    v_cvt_pk_bf16_f32 v38, 0, v38
    v_cvt_pk_bf16_f32 v39, 0, v39
    v_cvt_pk_bf16_f32 v40, 0, v40
    v_cvt_pk_bf16_f32 v41, 0, v41
    v_pk_mul_f32 v[32:33], v[32:33], v[208:209]
    v_pk_mul_f32 v[34:35], v[34:35], v[210:211]
    v_pk_mul_f32 v[36:37], v[36:37], v[212:213]
    v_pk_mul_f32 v[38:39], v[38:39], v[214:215]
    v_pk_mul_f32 v[40:41], v[40:41], v[216:217]
    v_cvt_pk_bf16_f32 v32, 0, v32
    v_cvt_pk_bf16_f32 v33, 0, v33
    v_cvt_pk_bf16_f32 v34, 0, v34
    v_cvt_pk_bf16_f32 v35, 0, v35
    v_cvt_pk_bf16_f32 v36, 0, v36
    v_cvt_pk_bf16_f32 v37, 0, v37
    v_cvt_pk_bf16_f32 v38, 0, v38
    v_cvt_pk_bf16_f32 v39, 0, v39
    v_cvt_pk_bf16_f32 v40, 0, v40
    v_cvt_pk_bf16_f32 v41, 0, v41
    v_pk_add_f32 v[32:33], v[32:33], v[218:219]
    v_pk_add_f32 v[34:35], v[34:35], v[220:221]
    v_pk_add_f32 v[36:37], v[36:37], v[222:223]
    v_pk_add_f32 v[38:39], v[38:39], v[224:225]
    v_pk_add_f32 v[40:41], v[40:41], v[226:227]
    v_cvt_pk_bf16_f32 v24, v32, v33
    ds_write_b32 v7, v24 offset:1024
    v_cvt_pk_bf16_f32 v25, v34, v35
    ds_write_b32 v7, v25 offset:3072
    v_cvt_pk_bf16_f32 v26, v36, v37
    ds_write_b32 v7, v26 offset:5120
    v_cvt_pk_bf16_f32 v27, v38, v39
    ds_write_b32 v7, v27 offset:7168
    v_cvt_pk_bf16_f32 v28, v40, v41
    ds_write_b32 v7, v28 offset:9216
    s_waitcnt lgkmcnt(0)
    s_barrier
    ds_read_b128 v[32:35], v186 offset:1024
    ds_read_b128 v[36:39], v186 offset:1536
    ds_read_b128 v[40:43], v186 offset:2048
    ds_read_b128 v[44:47], v186 offset:2560
    ds_read_b128 v[48:51], v186 offset:3072
    s_waitcnt lgkmcnt(4)
    v_mfma_f32_16x16x32_bf16 v[136:139], v[64:67], v[32:35], 0
    v_mfma_f32_16x16x32_bf16 v[140:143], v[68:71], v[32:35], 0
    s_waitcnt lgkmcnt(3)
    v_mfma_f32_16x16x32_bf16 v[136:139], v[72:75], v[36:39], v[136:139]
    v_mfma_f32_16x16x32_bf16 v[140:143], v[76:79], v[36:39], v[140:143]
    s_waitcnt lgkmcnt(2)
    v_mfma_f32_16x16x32_bf16 v[136:139], v[80:83], v[40:43], v[136:139]
    v_mfma_f32_16x16x32_bf16 v[140:143], v[84:87], v[40:43], v[140:143]
    s_waitcnt lgkmcnt(1)
    v_mfma_f32_16x16x32_bf16 v[136:139], v[88:91], v[44:47], v[136:139]
    v_mfma_f32_16x16x32_bf16 v[140:143], v[92:95], v[44:47], v[140:143]
    s_waitcnt lgkmcnt(0)
    v_mfma_f32_16x16x32_bf16 v[136:139], v[96:99], v[48:51], v[136:139]
    v_mfma_f32_16x16x32_bf16 v[140:143], v[100:103], v[48:51], v[140:143]
    s_nop 6
    ds_write_b128 v187, v[136:139]
    ds_write_b128 v187, v[140:143] offset:1024
    s_waitcnt lgkmcnt(0)
    s_barrier
    s_cmp_ge_u32 s3, 4
    s_cbranch_scc1 L_fin
    ds_read_b128 v[152:155], v188 offset:0
    ds_read_b128 v[156:159], v188 offset:4096
    ds_read_b128 v[160:163], v188 offset:8192
    ds_read_b128 v[164:167], v188 offset:12288
    ds_read_b128 v[168:171], v188 offset:2048
    ds_read_b128 v[172:175], v188 offset:6144
    ds_read_b128 v[176:179], v188 offset:10240
    ds_read_b128 v[180:183], v188 offset:14336
    s_waitcnt lgkmcnt(4)
    v_pk_add_f32 v[152:153], v[152:153], v[156:157]
    v_pk_add_f32 v[154:155], v[154:155], v[158:159]
    v_pk_add_f32 v[160:161], v[160:161], v[164:165]
    v_pk_add_f32 v[162:163], v[162:163], v[166:167]
    v_pk_add_f32 v[152:153], v[152:153], v[160:161]
    v_pk_add_f32 v[154:155], v[154:155], v[162:163]
    v_cvt_pk_bf16_f32 v32, 0, v152
    v_cvt_pk_bf16_f32 v33, 0, v153
    v_cvt_pk_bf16_f32 v34, 0, v154
    v_cvt_pk_bf16_f32 v35, 0, v155
    s_waitcnt lgkmcnt(0)
    v_pk_add_f32 v[168:169], v[168:169], v[172:173]
    v_pk_add_f32 v[170:171], v[170:171], v[174:175]
    v_pk_add_f32 v[176:177], v[176:177], v[180:181]
    v_pk_add_f32 v[178:179], v[178:179], v[182:183]
    v_pk_add_f32 v[168:169], v[168:169], v[176:177]
    v_pk_add_f32 v[170:171], v[170:171], v[178:179]
    v_cvt_pk_bf16_f32 v36, 0, v168
    v_cvt_pk_bf16_f32 v37, 0, v169
    v_cvt_pk_bf16_f32 v38, 0, v170
    v_cvt_pk_bf16_f32 v39, 0, v171
    s_mov_b32 s8, 0xbfb8aa3b
    v_pk_mul_f32 v[40:41], v[32:33], s[8:9] op_sel_hi:[1,0]
    v_pk_mul_f32 v[42:43], v[34:35], s[8:9] op_sel_hi:[1,0]
    v_pk_mul_f32 v[44:45], v[36:37], s[8:9] op_sel_hi:[1,0]
    v_pk_mul_f32 v[46:47], v[38:39], s[8:9] op_sel_hi:[1,0]
    v_exp_f32 v40, v40
    v_exp_f32 v41, v41
    v_exp_f32 v42, v42
    v_exp_f32 v43, v43
    v_exp_f32 v44, v44
    v_exp_f32 v45, v45
    v_exp_f32 v46, v46
    v_exp_f32 v47, v47
    v_pk_add_f32 v[40:41], v[40:41], 1.0 op_sel_hi:[1,0]
    v_pk_add_f32 v[42:43], v[42:43], 1.0 op_sel_hi:[1,0]
    v_pk_add_f32 v[44:45], v[44:45], 1.0 op_sel_hi:[1,0]
    v_pk_add_f32 v[46:47], v[46:47], 1.0 op_sel_hi:[1,0]
    v_rcp_f32 v40, v40
    v_rcp_f32 v41, v41
    v_rcp_f32 v42, v42
    v_rcp_f32 v43, v43
    v_rcp_f32 v44, v44
    v_rcp_f32 v45, v45
    v_rcp_f32 v46, v46
    v_rcp_f32 v47, v47
    v_pk_mul_f32 v[32:33], v[32:33], v[40:41]
    v_pk_mul_f32 v[34:35], v[34:35], v[42:43]
    v_pk_mul_f32 v[36:37], v[36:37], v[44:45]
    v_pk_mul_f32 v[38:39], v[38:39], v[46:47]
    v_cvt_pk_bf16_f32 v24, v32, v33
    v_cvt_pk_bf16_f32 v25, v34, v35
    v_cvt_pk_bf16_f32 v28, v36, v37
    v_cvt_pk_bf16_f32 v29, v38, v39
    v_mov_b32_dpp v26, v24 row_ror:8 row_mask:0xf bank_mask:0xf
    v_mov_b32_dpp v27, v25 row_ror:8 row_mask:0xf bank_mask:0xf
    v_mov_b32_dpp v30, v28 row_ror:8 row_mask:0xf bank_mask:0xf
    v_mov_b32_dpp v31, v29 row_ror:8 row_mask:0xf bank_mask:0xf
    v_mfma_f32_16x16x32_bf16 v[136:139], v[104:107], v[24:27], 0
    v_mfma_f32_16x16x32_bf16 v[140:143], v[112:115], v[24:27], 0
    v_mfma_f32_16x16x32_bf16 v[136:139], v[108:111], v[28:31], v[136:139]
    v_mfma_f32_16x16x32_bf16 v[140:143], v[116:119], v[28:31], v[140:143]
    v_mfma_f32_16x16x32_bf16 v[144:147], v[120:123], v[24:27], 0
    v_mfma_f32_16x16x32_bf16 v[148:151], v[128:131], v[24:27], 0
    v_mfma_f32_16x16x32_bf16 v[144:147], v[124:127], v[28:31], v[144:147]
    v_mfma_f32_16x16x32_bf16 v[148:151], v[132:135], v[28:31], v[148:151]
    s_mov_b64 exec, s[86:87]
    s_cmp_eq_u32 s93, 2
    s_nop 0
    v_min_u32 v136, -2, v136
    v_min_u32 v137, -2, v137
    v_min_u32 v138, -2, v138
    v_min_u32 v139, -2, v139
    buffer_store_dwordx4 v[136:139], v190, s[52:55], s42 offen offset:0 sc1
    v_min_u32 v140, -2, v140
    v_min_u32 v141, -2, v141
    v_min_u32 v142, -2, v142
    v_min_u32 v143, -2, v143
    buffer_store_dwordx4 v[140:143], v190, s[52:55], s42 offen offset:512 sc1
    s_cbranch_scc1 L_opd
    v_min_u32 v144, -2, v144
    v_min_u32 v145, -2, v145
    v_min_u32 v146, -2, v146
    v_min_u32 v147, -2, v147
    buffer_store_dwordx4 v[144:147], v190, s[52:55], s88 offen offset:0 sc1
    v_min_u32 v148, -2, v148
    v_min_u32 v149, -2, v149
    v_min_u32 v150, -2, v150
    v_min_u32 v151, -2, v151
    buffer_store_dwordx4 v[148:151], v190, s[52:55], s88 offen offset:512 sc1
L_opd:
    s_mov_b64 exec, -1
L_fin:
    s_cmp_eq_u32 s15, 0
    s_cbranch_scc1 L_noerr
    v_mov_b32 v8, s15
    s_mov_b64 exec, 1
    buffer_atomic_or v8, off, s[80:83], 0 offset:4 sc1
    s_mov_b64 exec, -1
L_noerr:
L_end:
    s_endpgm
.section .rodata,"a"
.p2align 6
.amdhsa_kernel adaLN_cond__sliding_block_cached__dense_activation_silu__decode_kernel
  .amdhsa_next_free_vgpr 256
  .amdhsa_next_free_sgpr 102
  .amdhsa_accum_offset 256
  .amdhsa_group_segment_fixed_size 0
  .amdhsa_kernarg_size 104
  .amdhsa_user_sgpr_count 2
  .amdhsa_user_sgpr_kernarg_segment_ptr 1
  .amdhsa_system_sgpr_workgroup_id_x 1
.end_amdhsa_kernel
```
